```python
import torch

def _softmax(x, axis=-1):
    return torch.softmax(x, dim=axis)
def _gelu(x):
    return torch.nn.functional.gelu(x, approximate="tanh")
def _silu(x):
    return torch.nn.functional.silu(x)
def _sigmoid(x):
    return torch.sigmoid(x)
def _layernorm(x, axis=-1, eps=1e-5):
    m = x.mean(dim=axis, keepdim=True)
    v = x.var(dim=axis, keepdim=True, unbiased=False)
    return (x - m) / torch.sqrt(v + eps)
def _scatter_add(tgt, idx, src, axis=0):
    return tgt.clone().index_add_(axis, idx, src)
def _segment_sum(src, seg, n):
    out = torch.zeros((n,) + src.shape[1:], dtype=src.dtype)
    return out.index_add_(0, seg, src)
def _pad(x, pw):
    flat = tuple(v for pair in reversed(pw) for v in pair)
    return torch.nn.functional.pad(x, flat)

kernel_name = 'standalone__mha_block_cached__near_ridge'

def setup_inputs():

    _w = (lambda a: (lambda t: t.to(torch.bfloat16) if t.is_floating_point() else t)(torch.as_tensor(a)))
    B, Sq, D = 8, 96, 1024
    H, Sk, Dh = 32, 512, 128
    return {
        "x": _w((lambda *s: torch.randn(*s, dtype=torch.bfloat16) * 0.8)(B, Sq, D)),
        "k_cache": _w((lambda *s: torch.randn(*s, dtype=torch.bfloat16) * 0.8)(B, H, Sk, Dh)),
        "v_cache": _w((lambda *s: torch.randn(*s, dtype=torch.bfloat16) * 0.05)(B, H, Sk, Dh)),
        "wq": _w((lambda *s: torch.randn(*s, dtype=torch.bfloat16) * 0.8)(D, H * Dh) * (D ** -0.5)),
        "wo": _w((lambda *s: torch.randn(*s, dtype=torch.bfloat16) * 0.05)(H * Dh, D) * ((H * Dh) ** -0.5)),
    }

def reference(x, k_cache, v_cache, wq, wo):
    B, Sq, D = x.shape
    H, Dh = 32, 128
    q = (lambda x, *d: x.permute(*d))((x @ wq).reshape(B, Sq, H, Dh), 0, 2, 1, 3)
    scores = torch.einsum("bhqd,bhkd->bhqk", q, k_cache) * (Dh ** -0.5)
    p = _softmax(scores, axis=-1)
    o = torch.einsum("bhqk,bhkd->bhqd", p, v_cache)
    return (lambda x, *d: x.permute(*d))(o, 0, 2, 1, 3).reshape(B, Sq, H * Dh) @ wo
```

```asm
; @launch grid=(256,1,1) block=(256,1,1) lds=163840
.amdgcn_target "amdgcn-amd-amdhsa--gfx950"
.text
.globl standalone__mha_block_cached__near_ridge_kernel
.p2align 8
.type standalone__mha_block_cached__near_ridge_kernel,@function
standalone__mha_block_cached__near_ridge_kernel:
    s_cmp_ge_u32 s2, 256
    s_cbranch_scc1 L_end
    s_load_dwordx4 s[4:7], s[0:1], 0
    s_load_dwordx4 s[8:11], s[0:1], 16
    s_load_dwordx4 s[12:15], s[0:1], 32
    s_load_dwordx4 s[16:19], s[0:1], 48
    v_lshrrev_b32 v1, 6, v0
    v_and_b32 v2, 63, v0
    v_readfirstlane_b32 s40, v1
    s_and_b32 s51, s2, 7
    s_lshr_b32 s52, s2, 3
    s_and_b32 s50, s51, 3
    s_lshr_b32 s51, s51, 2
    s_lshr_b32 s53, s52, 3
    s_and_b32 s42, s52, 7
    s_nop 0
    s_lshl_b32 s41, s51, 2
    s_add_u32 s41, s41, s53
    s_mul_i32 s43, s53, 4
    s_mul_i32 s44, s42, 2
    s_add_u32 s43, s43, s44
    s_lshr_b32 s43, s43, 0
    s_and_b32 s43, s43, 15
    s_lshl_b32 s47, s40, 12
    s_mul_i32 s48, s40, 3072
    s_add_u32 s48, s48, 65536
    s_lshl_b32 s54, s50, 3
    s_add_u32 s54, s54, s42
    s_lshl_b32 s57, s41, 5
    s_add_u32 s57, s57, s54
    s_lshl_b32 s58, s57, 17
    v_lshrrev_b32 v44, 4, v2
    v_lshl_add_u32 v49, v1, 4, v44
    v_lshlrev_b32 v49, 8, v49
    v_add_u32 v49, s58, v49
    v_mov_b32 v3, v49
    v_and_b32 v50, 15, v2
    v_add_u32 v51, 0, v44
    v_xor_b32 v51, v51, v50
    v_lshl_add_u32 v4, v51, 4, v49
    v_add_u32 v51, 4, v44
    v_xor_b32 v51, v51, v50
    v_lshl_add_u32 v5, v51, 4, v49
    v_add_u32 v51, 8, v44
    v_xor_b32 v51, v51, v50
    v_lshl_add_u32 v6, v51, 4, v49
    v_add_u32 v51, 12, v44
    v_xor_b32 v51, v51, v50
    v_lshl_add_u32 v7, v51, 4, v49
    s_waitcnt lgkmcnt(0)
    s_mov_b32 s28, s6
    s_mov_b32 s29, s7
    s_mov_b32 s30, 33554432
    s_mov_b32 s31, 0x00020000
    s_mov_b32 s49, 0
    s_add_u32 m0, s47, 114688
    s_nop 0
    buffer_load_dwordx4 v4, s[28:31], s49 offen offset:0 nt lds
    buffer_load_dwordx4 v5, s[28:31], s49 offen offset:1024 nt lds
    buffer_load_dwordx4 v6, s[28:31], s49 offen offset:2048 nt lds
    buffer_load_dwordx4 v7, s[28:31], s49 offen offset:3072 nt lds
    s_mov_b32 s49, 16384
    s_add_u32 m0, s47, 131072
    s_nop 0
    buffer_load_dwordx4 v4, s[28:31], s49 offen offset:0 nt lds
    buffer_load_dwordx4 v5, s[28:31], s49 offen offset:1024 nt lds
    buffer_load_dwordx4 v6, s[28:31], s49 offen offset:2048 nt lds
    buffer_load_dwordx4 v7, s[28:31], s49 offen offset:3072 nt lds
    s_mov_b32 s49, 32768
    s_add_u32 m0, s47, 147456
    s_nop 0
    buffer_load_dwordx4 v4, s[28:31], s49 offen offset:0 nt lds
    buffer_load_dwordx4 v5, s[28:31], s49 offen offset:1024 nt lds
    buffer_load_dwordx4 v6, s[28:31], s49 offen offset:2048 nt lds
    buffer_load_dwordx4 v7, s[28:31], s49 offen offset:3072 nt lds
    s_mov_b32 s49, 49152
    s_add_u32 m0, s47, 49152
    s_nop 0
    buffer_load_dwordx4 v4, s[28:31], s49 offen offset:0 nt lds
    buffer_load_dwordx4 v5, s[28:31], s49 offen offset:1024 nt lds
    buffer_load_dwordx4 v6, s[28:31], s49 offen offset:2048 nt lds
    buffer_load_dwordx4 v7, s[28:31], s49 offen offset:3072 nt lds
    s_mov_b32 s49, 65536
    s_add_u32 m0, s47, 16384
    s_nop 0
    buffer_load_dwordx4 v4, s[28:31], s49 offen offset:0 nt lds
    buffer_load_dwordx4 v5, s[28:31], s49 offen offset:1024 nt lds
    buffer_load_dwordx4 v6, s[28:31], s49 offen offset:2048 nt lds
    buffer_load_dwordx4 v7, s[28:31], s49 offen offset:3072 nt lds
    s_mov_b32 s49, 81920
    s_add_u32 m0, s47, 32768
    s_nop 0
    buffer_load_dwordx4 v4, s[28:31], s49 offen offset:0 nt lds
    buffer_load_dwordx4 v5, s[28:31], s49 offen offset:1024 nt lds
    buffer_load_dwordx4 v6, s[28:31], s49 offen offset:2048 nt lds
    buffer_load_dwordx4 v7, s[28:31], s49 offen offset:3072 nt lds
    v_lshrrev_b32 v44, 4, v2
    v_and_b32 v45, 15, v2
    v_lshlrev_b32 v46, 2, v44
    v_xor_b32 v45, v45, v46
    v_lshlrev_b32 v45, 4, v45
    v_bfe_u32 v47, v2, 2, 2
    v_lshrrev_b32 v48, 5, v2
    v_xor_b32 v46, v1, v47
    v_lshlrev_b32 v46, 6, v46
    v_and_b32 v49, 1, v44
    v_lshl_add_u32 v46, v49, 5, v46
    v_and_b32 v49, 1, v2
    v_lshl_add_u32 v46, v49, 4, v46
    v_bfe_u32 v49, v2, 1, 1
    v_lshl_add_u32 v46, v49, 3, v46
    v_lshlrev_b32 v21, 4, v2
    s_lshl_b32 s55, s54, 8
    s_mul_i32 s56, s41, 196608
    v_add_u32 v3, v3, v45
    s_mul_i32 s80, s2, 12288
    s_lshl_b32 s82, s40, 10
    s_add_u32 s80, s80, s82
    s_add_u32 s80, s80, 9437184
    s_add_u32 s97, s80, 4096
    s_add_u32 s98, s80, 8192
    s_mul_i32 s58, s57, 24576
    s_add_u32 s59, s58, 8192
    s_add_u32 s81, s58, 16384
    v_mov_b32 v252, -1
    v_mov_b32 v253, -1
    v_mov_b32 v254, -1
    v_mov_b32 v255, -1
    v_lshl_add_u32 v28, v1, 11, v21
    s_mov_b32 s36, s18
    s_mov_b32 s37, s19
    s_mov_b32 s38, 268435456
    s_mov_b32 s39, 0x00020000
    v_lshl_add_u32 v49, v1, 4, v44
    v_lshlrev_b32 v49, 13, v49
    v_add3_u32 v240, v49, v45, s55
    v_add_u32 v241, 31744, v240
    v_add_u32 v242, 63488, v240
    v_add_u32 v243, 95232, v240
    v_lshl_add_u32 v49, v48, 3, v47
    v_lshl_add_u32 v247, v49, 8, v46
    v_mul_u32_u24 v49, 24, v1
    v_lshrrev_b32 v50, 3, v2
    v_add_u32 v49, v49, v50
    v_and_b32 v51, 7, v2
    v_add_u32 v50, 0, v49
    v_bfe_u32 v52, v50, 1, 3
    v_xor_b32 v52, v52, v51
    v_lshlrev_b32 v52, 4, v52
    v_lshl_add_u32 v52, v50, 11, v52
    v_subrev_u32 v244, 0, v52
    v_add_u32 v50, 8, v49
    v_bfe_u32 v52, v50, 1, 3
    v_xor_b32 v52, v52, v51
    v_lshlrev_b32 v52, 4, v52
    v_lshl_add_u32 v52, v50, 11, v52
    v_subrev_u32 v245, 1024, v52
    v_add_u32 v50, 16, v49
    v_bfe_u32 v52, v50, 1, 3
    v_xor_b32 v52, v52, v51
    v_lshlrev_b32 v52, 4, v52
    v_lshl_add_u32 v52, v50, 11, v52
    v_subrev_u32 v246, 2048, v52
    v_and_b32 v49, 31, v2
    v_bfe_u32 v50, v2, 1, 3
    v_xor_b32 v50, v50, v48
    v_lshlrev_b32 v50, 4, v50
    v_lshl_add_u32 v50, v49, 7, v50
    v_add_u32 v248, 0x10000, v50
    v_xor_b32 v249, 32, v248
    v_xor_b32 v250, 64, v248
    v_xor_b32 v251, 96, v248
    s_mov_b32 s20, s4
    s_mov_b32 s21, s5
    s_mov_b32 s22, 1572864
    s_mov_b32 s23, 0x00020000
    s_mov_b32 s24, s10
    s_mov_b32 s25, s11
    s_mov_b32 s26, 8388608
    s_mov_b32 s27, 0x00020000
    v_and_b32 v50, 15, v2
    v_xor_b32 v49, v48, v50
    v_lshlrev_b32 v49, 4, v49
    v_lshl_add_u32 v49, v50, 8, v49
    v_lshl_add_u32 v49, v1, 12, v49
    v_bfe_u32 v51, v2, 4, 1
    v_mul_i32_i24 v52, 0x4000, v51
    v_add_u32 v52, v49, v52
    v_add_u32 v9, 114688, v52
    v_mul_i32_i24 v52, 0xfffe8000, v51
    v_add_u32 v52, v49, v52
    v_add_u32 v10, 147456, v52
    v_mul_i32_i24 v52, 0x4000, v51
    v_add_u32 v52, v49, v52
    v_add_u32 v11, 16384, v52
    v_mul_i32_i24 v52, 0x4000, v51
    v_add_u32 v52, v49, v52
    v_add_u32 v12, 114688, v52
    s_waitcnt vmcnt(16)
    ds_read_b128 a[0:3], v9
    v_xor_b32 v13, 32, v9
    ds_read_b128 a[4:7], v13
    v_xor_b32 v14, 64, v9
    ds_read_b128 a[8:11], v14
    v_xor_b32 v15, 96, v9
    ds_read_b128 a[12:15], v15
    v_xor_b32 v16, 128, v9
    ds_read_b128 a[16:19], v16
    v_xor_b32 v17, 160, v9
    ds_read_b128 a[20:23], v17
    v_xor_b32 v18, 192, v9
    ds_read_b128 a[24:27], v18
    v_xor_b32 v19, 224, v9
    ds_read_b128 a[28:31], v19
    s_waitcnt lgkmcnt(0)
    s_mov_b32 s49, 98304
    s_add_u32 m0, s47, 114688
    s_nop 0
    buffer_load_dwordx4 v4, s[28:31], s49 offen offset:0 nt lds
    buffer_load_dwordx4 v5, s[28:31], s49 offen offset:1024 nt lds
    buffer_load_dwordx4 v6, s[28:31], s49 offen offset:2048 nt lds
    buffer_load_dwordx4 v7, s[28:31], s49 offen offset:3072 nt lds
    s_mov_b32 s49, 114688
    s_add_u32 m0, s47, 131072
    s_nop 0
    buffer_load_dwordx4 v4, s[28:31], s49 offen offset:0 nt lds
    buffer_load_dwordx4 v5, s[28:31], s49 offen offset:1024 nt lds
    buffer_load_dwordx4 v6, s[28:31], s49 offen offset:2048 nt lds
    buffer_load_dwordx4 v7, s[28:31], s49 offen offset:3072 nt lds
    s_lshl_b32 s45, s43, 19
    s_mul_i32 s46, s43, 128
    s_add_u32 s46, s46, s56
    s_add_u32 s43, s43, 1
    s_and_b32 s43, s43, 15
    s_add_u32 m0, s47, 0
    s_nop 0
    buffer_load_dwordx4 v240, s[24:27], s45 offen  lds
    buffer_load_dwordx4 v241, s[24:27], s45 offen offset:1024  lds
    buffer_load_dwordx4 v242, s[24:27], s45 offen offset:2048  lds
    buffer_load_dwordx4 v243, s[24:27], s45 offen offset:3072  lds
    s_add_u32 m0, s48, 0
    s_nop 0
    buffer_load_dwordx4 v244, s[20:23], s46 offen offset:0  lds
    buffer_load_dwordx4 v245, s[20:23], s46 offen offset:1024  lds
    buffer_load_dwordx4 v246, s[20:23], s46 offen offset:2048  lds
    s_waitcnt vmcnt(23)
    ds_read_b128 a[32:35], v10
    v_xor_b32 v13, 32, v10
    ds_read_b128 a[36:39], v13
    v_xor_b32 v14, 64, v10
    ds_read_b128 a[40:43], v14
    v_xor_b32 v15, 96, v10
    ds_read_b128 a[44:47], v15
    v_xor_b32 v16, 128, v10
    ds_read_b128 a[48:51], v16
    v_xor_b32 v17, 160, v10
    ds_read_b128 a[52:55], v17
    v_xor_b32 v18, 192, v10
    ds_read_b128 a[56:59], v18
    v_xor_b32 v19, 224, v10
    ds_read_b128 a[60:63], v19
    s_waitcnt vmcnt(15)
    ds_read_b128 a[64:67], v11
    v_xor_b32 v13, 32, v11
    ds_read_b128 a[68:71], v13
    v_xor_b32 v14, 64, v11
    ds_read_b128 a[72:75], v14
    v_xor_b32 v15, 96, v11
    ds_read_b128 a[76:79], v15
    v_xor_b32 v16, 128, v11
    ds_read_b128 a[80:83], v16
    v_xor_b32 v17, 160, v11
    ds_read_b128 a[84:87], v17
    v_xor_b32 v18, 192, v11
    ds_read_b128 a[88:91], v18
    v_xor_b32 v19, 224, v11
    ds_read_b128 a[92:95], v19
    s_waitcnt lgkmcnt(0)
    s_lshl_b32 s45, s43, 19
    s_mul_i32 s46, s43, 128
    s_add_u32 s46, s46, s56
    s_add_u32 s43, s43, 1
    s_and_b32 s43, s43, 15
    s_add_u32 m0, s47, 16384
    s_nop 0
    buffer_load_dwordx4 v240, s[24:27], s45 offen  lds
    buffer_load_dwordx4 v241, s[24:27], s45 offen offset:1024  lds
    buffer_load_dwordx4 v242, s[24:27], s45 offen offset:2048  lds
    buffer_load_dwordx4 v243, s[24:27], s45 offen offset:3072  lds
    s_add_u32 m0, s48, 12288
    s_nop 0
    buffer_load_dwordx4 v244, s[20:23], s46 offen offset:0  lds
    buffer_load_dwordx4 v245, s[20:23], s46 offen offset:1024  lds
    buffer_load_dwordx4 v246, s[20:23], s46 offen offset:2048  lds
    s_lshl_b32 s45, s43, 19
    s_mul_i32 s46, s43, 128
    s_add_u32 s46, s46, s56
    s_add_u32 s43, s43, 1
    s_and_b32 s43, s43, 15
    s_add_u32 m0, s47, 32768
    s_nop 0
    buffer_load_dwordx4 v240, s[24:27], s45 offen  lds
    buffer_load_dwordx4 v241, s[24:27], s45 offen offset:1024  lds
    buffer_load_dwordx4 v242, s[24:27], s45 offen offset:2048  lds
    buffer_load_dwordx4 v243, s[24:27], s45 offen offset:3072  lds
    s_add_u32 m0, s48, 24576
    s_nop 0
    buffer_load_dwordx4 v244, s[20:23], s46 offen offset:0  lds
    buffer_load_dwordx4 v245, s[20:23], s46 offen offset:1024  lds
    buffer_load_dwordx4 v246, s[20:23], s46 offen offset:2048  lds
    s_lshl_b32 s45, s43, 19
    s_mul_i32 s46, s43, 128
    s_add_u32 s46, s46, s56
    s_add_u32 s43, s43, 1
    s_and_b32 s43, s43, 15
    s_add_u32 m0, s47, 49152
    s_nop 0
    buffer_load_dwordx4 v240, s[24:27], s45 offen  lds
    buffer_load_dwordx4 v241, s[24:27], s45 offen offset:1024  lds
    buffer_load_dwordx4 v242, s[24:27], s45 offen offset:2048  lds
    buffer_load_dwordx4 v243, s[24:27], s45 offen offset:3072  lds
    s_add_u32 m0, s48, 36864
    s_nop 0
    buffer_load_dwordx4 v244, s[20:23], s46 offen offset:0  lds
    buffer_load_dwordx4 v245, s[20:23], s46 offen offset:1024  lds
    buffer_load_dwordx4 v246, s[20:23], s46 offen offset:2048  lds
    s_mov_b32 s32, s8
    s_mov_b32 s33, s9
    s_mov_b32 s34, 33554432
    s_mov_b32 s35, 0x00020000
    s_mov_b32 s68, s12
    s_mov_b32 s69, s13
    s_mov_b32 s70, 8388608
    s_mov_b32 s71, 0x00020000
    s_mov_b32 s72, s14
    s_mov_b32 s73, s15
    s_mov_b32 s74, 1572864
    s_mov_b32 s75, 0x00020000
    s_mov_b32 s76, s16
    s_mov_b32 s77, s17
    s_mov_b32 s78, 256
    s_mov_b32 s79, 0x00020000
    v_mov_b32 v29, 1
    s_lshl_b32 s83, s41, 5
    v_lshl_add_u32 v49, v48, 2, v47
    v_lshl_add_u32 v8, v49, 8, v46
    v_add_u32 v42, 0x10000, v8
    v_add_u32 v43, 0x20000, v8
    v_lshl_add_u32 v22, v1, 13, v21
    v_and_b32 v49, 31, v2
    v_lshlrev_b32 v49, 4, v49
    v_add_u32 v24, 30720, v49
    v_lshl_add_u32 v23, v1, 2, v24
    s_mov_b32 s64, 0x3e0293ee
    s_mov_b32 s65, 0x3e0293ee
    s_mov_b32 s66, 0xbe0293ee
    s_bfe_u32 s84, s2, 0x10001
    s_xor_b32 s84, s84, 1
    s_and_b32 s85, s2, 1
    s_lshl_b32 s85, s85, 3
    s_add_u32 s85, s85, s42
    s_lshl_b32 s86, s84, 22
    s_lshl_b32 s82, s85, 7
    s_add_u32 s86, s86, s82
    s_lshl_b32 s87, s41, 5
    s_lshl_b32 s82, s84, 4
    s_add_u32 s87, s87, s82
    s_lshl_b32 s82, s40, 2
    s_add_u32 s87, s87, s82
    s_mul_i32 s87, s87, 24576
    s_xor_b32 s88, s2, 2
    s_mul_i32 s88, s88, 12288
    s_lshl_b32 s82, s40, 10
    s_add_u32 s88, s88, s82
    s_add_u32 s88, s88, 9437184
    s_add_u32 s95, s88, 4096
    s_add_u32 s96, s88, 8192
    s_mul_i32 s89, s41, 196608
    s_lshl_b32 s82, s85, 7
    s_add_u32 s89, s89, s82
    s_lshl_b32 s82, s84, 6
    s_add_u32 s89, s89, s82
    s_lshr_b32 s82, s40, 1
    s_lshl_b32 s82, s82, 5
    s_add_u32 s89, s89, s82
    s_and_b32 s82, s40, 1
    s_lshl_b32 s82, s82, 3
    s_add_u32 s89, s89, s82
    v_lshl_add_u32 v49, v48, 3, v47
    v_lshlrev_b32 v49, 7, v49
    v_and_b32 v50, 63, v46
    v_add_u32 v49, v49, v50
    v_bfe_u32 v50, v2, 3, 1
    v_lshl_add_u32 v49, v50, 6, v49
    v_lshl_add_u32 v56, v1, 12, v49
    v_lshrrev_b32 v49, 3, v2
    v_lshl_add_u32 v49, v1, 9, v49
    v_lshlrev_b32 v49, 11, v49
    v_and_b32 v50, 7, v2
    v_bfe_u32 v51, v2, 4, 1
    v_lshlrev_b32 v51, 2, v51
    v_xor_b32 v50, v50, v51
    v_lshl_add_u32 v57, v50, 4, v49
    s_lshl_b32 s82, s53, 9
    v_lshl_add_u32 v49, v1, 7, v2
    v_add_u32 v49, s82, v49
    v_lshlrev_b32 v58, 11, v49
    v_bfe_u32 v49, v2, 2, 2
    v_and_b32 v50, 3, v2
    v_lshlrev_b32 v50, 2, v50
    v_lshl_add_u32 v59, v49, 7, v50
    v_and_b32 v49, 31, v2
    v_lshlrev_b32 v49, 11, v49
    v_lshl_add_u32 v60, v48, 4, v49
    s_waitcnt vmcnt(21)
    s_barrier
    ds_read_b64_tr_b16 v[112:113], v247 offset:0
    ds_read_b64_tr_b16 v[114:115], v247 offset:1024
    ds_read_b128 v[144:147], v248 offset:0
    ds_read_b128 v[148:151], v248 offset:4096
    ds_read_b128 v[152:155], v248 offset:8192
    ds_read_b64_tr_b16 v[116:117], v247 offset:4096
    ds_read_b64_tr_b16 v[118:119], v247 offset:5120
    ds_read_b128 v[156:159], v249 offset:0
    ds_read_b128 v[160:163], v249 offset:4096
    ds_read_b128 v[164:167], v249 offset:8192
    ds_read_b64_tr_b16 v[120:121], v247 offset:8192
    ds_read_b64_tr_b16 v[122:123], v247 offset:9216
    ds_read_b128 v[168:171], v250 offset:0
    ds_read_b128 v[172:175], v250 offset:4096
    ds_read_b128 v[176:179], v250 offset:8192
    ds_read_b64_tr_b16 v[124:125], v247 offset:12288
    ds_read_b64_tr_b16 v[126:127], v247 offset:13312
    ds_read_b128 v[180:183], v251 offset:0
    ds_read_b128 v[184:187], v251 offset:4096
    ds_read_b128 v[188:191], v251 offset:8192
    s_waitcnt vmcnt(14) lgkmcnt(0)
    s_barrier
    s_lshl_b32 s45, s43, 19
    s_mul_i32 s46, s43, 128
    s_add_u32 s46, s46, s56
    s_add_u32 s43, s43, 1
    s_and_b32 s43, s43, 15
    s_add_u32 m0, s47, 0
    s_nop 0
    buffer_load_dwordx4 v240, s[24:27], s45 offen  lds
    v_mfma_f32_32x32x16_bf16 v[64:79], v[112:115], v[144:147], 0
    ds_read_b64_tr_b16 v[128:129], v247 offset:16384
    ds_read_b64_tr_b16 v[130:131], v247 offset:17408
    buffer_load_dwordx4 v241, s[24:27], s45 offen offset:1024  lds
    v_mfma_f32_32x32x16_bf16 v[80:95], v[112:115], v[148:151], 0
    ds_read_b128 v[192:195], v248 offset:12288
    buffer_load_dwordx4 v242, s[24:27], s45 offen offset:2048  lds
    ds_read_b128 v[196:199], v248 offset:16384
    v_mfma_f32_32x32x16_bf16 v[96:111], v[112:115], v[152:155], 0
    buffer_load_dwordx4 v243, s[24:27], s45 offen offset:3072  lds
    ds_read_b128 v[200:203], v248 offset:20480
    s_add_u32 m0, s48, 0
    s_nop 0
    buffer_load_dwordx4 v244, s[20:23], s46 offen offset:0  lds
    v_mfma_f32_32x32x16_bf16 v[64:79], v[116:119], v[156:159], v[64:79]
    ds_read_b64_tr_b16 v[132:133], v247 offset:20480
    buffer_load_dwordx4 v245, s[20:23], s46 offen offset:1024  lds
    ds_read_b64_tr_b16 v[134:135], v247 offset:21504
    v_mfma_f32_32x32x16_bf16 v[80:95], v[116:119], v[160:163], v[80:95]
    ds_read_b128 v[204:207], v249 offset:12288
    buffer_load_dwordx4 v246, s[20:23], s46 offen offset:2048  lds
    ds_read_b128 v[208:211], v249 offset:16384
    v_mfma_f32_32x32x16_bf16 v[96:111], v[116:119], v[164:167], v[96:111]
    ds_read_b128 v[212:215], v249 offset:20480
    v_mfma_f32_32x32x16_bf16 v[64:79], v[120:123], v[168:171], v[64:79]
    ds_read_b64_tr_b16 v[136:137], v247 offset:24576
    ds_read_b128 a[96:99], v12
    ds_read_b64_tr_b16 v[138:139], v247 offset:25600
    v_mfma_f32_32x32x16_bf16 v[80:95], v[120:123], v[172:175], v[80:95]
    v_xor_b32 v13, 32, v12
    ds_read_b128 a[100:103], v13
    ds_read_b128 v[216:219], v250 offset:12288
    v_xor_b32 v14, 64, v12
    ds_read_b128 a[104:107], v14
    v_mfma_f32_32x32x16_bf16 v[96:111], v[120:123], v[176:179], v[96:111]
    ds_read_b128 v[220:223], v250 offset:16384
    ds_read_b128 v[224:227], v250 offset:20480
    v_xor_b32 v15, 96, v12
    ds_read_b128 a[108:111], v15
    v_mfma_f32_32x32x16_bf16 v[64:79], v[124:127], v[180:183], v[64:79]
    ds_read_b64_tr_b16 v[140:141], v247 offset:28672
    v_xor_b32 v16, 128, v12
    ds_read_b128 a[112:115], v16
    ds_read_b64_tr_b16 v[142:143], v247 offset:29696
    v_mfma_f32_32x32x16_bf16 v[80:95], v[124:127], v[184:187], v[80:95]
    v_xor_b32 v17, 160, v12
    ds_read_b128 a[116:119], v17
    ds_read_b128 v[228:231], v251 offset:12288
    v_xor_b32 v18, 192, v12
    ds_read_b128 a[120:123], v18
    v_mfma_f32_32x32x16_bf16 v[96:111], v[124:127], v[188:191], v[96:111]
    ds_read_b128 v[232:235], v251 offset:16384
    v_xor_b32 v19, 224, v12
    ds_read_b128 a[124:127], v19
    ds_read_b128 v[236:239], v251 offset:20480
    s_waitcnt vmcnt(14) lgkmcnt(0)
    s_barrier
    s_lshl_b32 s45, s43, 19
    s_mul_i32 s46, s43, 128
    s_add_u32 s46, s46, s56
    s_add_u32 s43, s43, 1
    s_and_b32 s43, s43, 15
    s_add_u32 m0, s47, 16384
    s_nop 0
    buffer_load_dwordx4 v240, s[24:27], s45 offen  lds
    v_mfma_f32_32x32x16_bf16 v[64:79], v[128:131], v[192:195], v[64:79]
    ds_read_b64_tr_b16 v[112:113], v247 offset:32768
    ds_read_b64_tr_b16 v[114:115], v247 offset:33792
    ds_read_b128 v[144:147], v248 offset:24576
    v_mfma_f32_32x32x16_bf16 v[80:95], v[128:131], v[196:199], v[80:95]
    buffer_load_dwordx4 v241, s[24:27], s45 offen offset:1024  lds
    ds_read_b128 v[148:151], v248 offset:28672
    v_mfma_f32_32x32x16_bf16 v[96:111], v[128:131], v[200:203], v[96:111]
    ds_read_b128 v[152:155], v248 offset:32768
    buffer_load_dwordx4 v242, s[24:27], s45 offen offset:2048  lds
    v_mfma_f32_32x32x16_bf16 v[64:79], v[132:135], v[204:207], v[64:79]
    ds_read_b64_tr_b16 v[116:117], v247 offset:36864
    ds_read_b64_tr_b16 v[118:119], v247 offset:37888
    buffer_load_dwordx4 v243, s[24:27], s45 offen offset:3072  lds
    v_mfma_f32_32x32x16_bf16 v[80:95], v[132:135], v[208:211], v[80:95]
    ds_read_b128 v[156:159], v249 offset:24576
    ds_read_b128 v[160:163], v249 offset:28672
    v_mfma_f32_32x32x16_bf16 v[96:111], v[132:135], v[212:215], v[96:111]
    s_add_u32 m0, s48, 12288
    s_nop 0
    buffer_load_dwordx4 v244, s[20:23], s46 offen offset:0  lds
    ds_read_b128 v[164:167], v249 offset:32768
    v_mfma_f32_32x32x16_bf16 v[64:79], v[136:139], v[216:219], v[64:79]
    ds_read_b64_tr_b16 v[120:121], v247 offset:40960
    ds_read_b64_tr_b16 v[122:123], v247 offset:41984
    buffer_load_dwordx4 v245, s[20:23], s46 offen offset:1024  lds
    v_mfma_f32_32x32x16_bf16 v[80:95], v[136:139], v[220:223], v[80:95]
    ds_read_b128 v[168:171], v250 offset:24576
    ds_read_b128 v[172:175], v250 offset:28672
    v_mfma_f32_32x32x16_bf16 v[96:111], v[136:139], v[224:227], v[96:111]
    buffer_load_dwordx4 v246, s[20:23], s46 offen offset:2048  lds
    ds_read_b128 v[176:179], v250 offset:32768
    v_mfma_f32_32x32x16_bf16 v[64:79], v[140:143], v[228:231], v[64:79]
    ds_read_b64_tr_b16 v[124:125], v247 offset:45056
    ds_read_b64_tr_b16 v[126:127], v247 offset:46080
    v_mfma_f32_32x32x16_bf16 v[80:95], v[140:143], v[232:235], v[80:95]
    ds_read_b128 v[180:183], v251 offset:24576
    buffer_store_dwordx4 v[252:255], v28, s[36:39], s58 offen offset:0 sc1
    v_mfma_f32_32x32x16_bf16 v[96:111], v[140:143], v[236:239], v[96:111]
    ds_read_b128 v[184:187], v251 offset:28672
    ds_read_b128 v[188:191], v251 offset:32768
    s_waitcnt vmcnt(15) lgkmcnt(0)
    s_barrier
    s_lshl_b32 s45, s43, 19
    s_mul_i32 s46, s43, 128
    s_add_u32 s46, s46, s56
    s_add_u32 s43, s43, 1
    s_and_b32 s43, s43, 15
    s_add_u32 m0, s47, 32768
    s_nop 0
    buffer_load_dwordx4 v240, s[24:27], s45 offen  lds
    v_mfma_f32_32x32x16_bf16 v[64:79], v[112:115], v[144:147], v[64:79]
    ds_read_b64_tr_b16 v[128:129], v247 offset:49152
    ds_read_b64_tr_b16 v[130:131], v247 offset:50176
    ds_read_b128 v[192:195], v248 offset:36864
    v_mfma_f32_32x32x16_bf16 v[80:95], v[112:115], v[148:151], v[80:95]
    buffer_load_dwordx4 v241, s[24:27], s45 offen offset:1024  lds
    ds_read_b128 v[196:199], v248 offset:40960
    v_mfma_f32_32x32x16_bf16 v[96:111], v[112:115], v[152:155], v[96:111]
    ds_read_b128 v[200:203], v248 offset:45056
    buffer_load_dwordx4 v242, s[24:27], s45 offen offset:2048  lds
    v_mfma_f32_32x32x16_bf16 v[64:79], v[116:119], v[156:159], v[64:79]
    ds_read_b64_tr_b16 v[132:133], v247 offset:53248
    ds_read_b64_tr_b16 v[134:135], v247 offset:54272
    buffer_load_dwordx4 v243, s[24:27], s45 offen offset:3072  lds
    v_mfma_f32_32x32x16_bf16 v[80:95], v[116:119], v[160:163], v[80:95]
    ds_read_b128 v[204:207], v249 offset:36864
    ds_read_b128 v[208:211], v249 offset:40960
    v_mfma_f32_32x32x16_bf16 v[96:111], v[116:119], v[164:167], v[96:111]
    s_add_u32 m0, s48, 24576
    s_nop 0
    buffer_load_dwordx4 v244, s[20:23], s46 offen offset:0  lds
    ds_read_b128 v[212:215], v249 offset:45056
    v_mfma_f32_32x32x16_bf16 v[64:79], v[120:123], v[168:171], v[64:79]
    ds_read_b64_tr_b16 v[136:137], v247 offset:57344
    ds_read_b64_tr_b16 v[138:139], v247 offset:58368
    buffer_load_dwordx4 v245, s[20:23], s46 offen offset:1024  lds
    v_mfma_f32_32x32x16_bf16 v[80:95], v[120:123], v[172:175], v[80:95]
    ds_read_b128 v[216:219], v250 offset:36864
    ds_read_b128 v[220:223], v250 offset:40960
    v_mfma_f32_32x32x16_bf16 v[96:111], v[120:123], v[176:179], v[96:111]
    buffer_load_dwordx4 v246, s[20:23], s46 offen offset:2048  lds
    ds_read_b128 v[224:227], v250 offset:45056
    v_mfma_f32_32x32x16_bf16 v[64:79], v[124:127], v[180:183], v[64:79]
    ds_read_b64_tr_b16 v[140:141], v247 offset:61440
    ds_read_b64_tr_b16 v[142:143], v247 offset:62464
    v_mfma_f32_32x32x16_bf16 v[80:95], v[124:127], v[184:187], v[80:95]
    ds_read_b128 v[228:231], v251 offset:36864
    buffer_store_dwordx4 v[252:255], v28, s[36:39], s58 offen offset:1024 sc1
    v_mfma_f32_32x32x16_bf16 v[96:111], v[124:127], v[188:191], v[96:111]
    ds_read_b128 v[232:235], v251 offset:40960
    ds_read_b128 v[236:239], v251 offset:45056
    s_waitcnt vmcnt(16) lgkmcnt(0)
    s_barrier
    s_lshl_b32 s45, s43, 19
    s_mul_i32 s46, s43, 128
    s_add_u32 s46, s46, s56
    s_add_u32 s43, s43, 1
    s_and_b32 s43, s43, 15
    s_add_u32 m0, s47, 49152
    s_nop 0
    buffer_load_dwordx4 v240, s[24:27], s45 offen  lds
    v_mfma_f32_32x32x16_bf16 v[64:79], v[128:131], v[192:195], v[64:79]
    ds_read_b64_tr_b16 v[112:113], v247 offset:0
    ds_read_b64_tr_b16 v[114:115], v247 offset:1024
    ds_read_b128 v[144:147], v248 offset:0
    v_mfma_f32_32x32x16_bf16 v[80:95], v[128:131], v[196:199], v[80:95]
    buffer_load_dwordx4 v241, s[24:27], s45 offen offset:1024  lds
    ds_read_b128 v[148:151], v248 offset:4096
    v_mfma_f32_32x32x16_bf16 v[96:111], v[128:131], v[200:203], v[96:111]
    ds_read_b128 v[152:155], v248 offset:8192
    buffer_load_dwordx4 v242, s[24:27], s45 offen offset:2048  lds
    v_mfma_f32_32x32x16_bf16 v[64:79], v[132:135], v[204:207], v[64:79]
    ds_read_b64_tr_b16 v[116:117], v247 offset:4096
    ds_read_b64_tr_b16 v[118:119], v247 offset:5120
    buffer_load_dwordx4 v243, s[24:27], s45 offen offset:3072  lds
    v_mfma_f32_32x32x16_bf16 v[80:95], v[132:135], v[208:211], v[80:95]
    ds_read_b128 v[156:159], v249 offset:0
    ds_read_b128 v[160:163], v249 offset:4096
    v_mfma_f32_32x32x16_bf16 v[96:111], v[132:135], v[212:215], v[96:111]
    s_add_u32 m0, s48, 36864
    s_nop 0
    buffer_load_dwordx4 v244, s[20:23], s46 offen offset:0  lds
    ds_read_b128 v[164:167], v249 offset:8192
    v_mfma_f32_32x32x16_bf16 v[64:79], v[136:139], v[216:219], v[64:79]
    ds_read_b64_tr_b16 v[120:121], v247 offset:8192
    ds_read_b64_tr_b16 v[122:123], v247 offset:9216
    buffer_load_dwordx4 v245, s[20:23], s46 offen offset:1024  lds
    v_mfma_f32_32x32x16_bf16 v[80:95], v[136:139], v[220:223], v[80:95]
    ds_read_b128 v[168:171], v250 offset:0
    ds_read_b128 v[172:175], v250 offset:4096
    v_mfma_f32_32x32x16_bf16 v[96:111], v[136:139], v[224:227], v[96:111]
    buffer_load_dwordx4 v246, s[20:23], s46 offen offset:2048  lds
    ds_read_b128 v[176:179], v250 offset:8192
    v_mfma_f32_32x32x16_bf16 v[64:79], v[140:143], v[228:231], v[64:79]
    ds_read_b64_tr_b16 v[124:125], v247 offset:12288
    ds_read_b64_tr_b16 v[126:127], v247 offset:13312
    v_mfma_f32_32x32x16_bf16 v[80:95], v[140:143], v[232:235], v[80:95]
    ds_read_b128 v[180:183], v251 offset:0
    buffer_store_dwordx4 v[252:255], v28, s[36:39], s59 offen offset:0 sc1
    v_mfma_f32_32x32x16_bf16 v[96:111], v[140:143], v[236:239], v[96:111]
    ds_read_b128 v[184:187], v251 offset:4096
    ds_read_b128 v[188:191], v251 offset:8192
    s_waitcnt vmcnt(17) lgkmcnt(0)
    s_barrier
    s_lshl_b32 s45, s43, 19
    s_mul_i32 s46, s43, 128
    s_add_u32 s46, s46, s56
    s_add_u32 s43, s43, 1
    s_and_b32 s43, s43, 15
    s_add_u32 m0, s47, 0
    s_nop 0
    buffer_load_dwordx4 v240, s[24:27], s45 offen  lds
    v_mfma_f32_32x32x16_bf16 v[64:79], v[112:115], v[144:147], v[64:79]
    ds_read_b64_tr_b16 v[128:129], v247 offset:16384
    ds_read_b64_tr_b16 v[130:131], v247 offset:17408
    ds_read_b128 v[192:195], v248 offset:12288
    v_mfma_f32_32x32x16_bf16 v[80:95], v[112:115], v[148:151], v[80:95]
    buffer_load_dwordx4 v241, s[24:27], s45 offen offset:1024  lds
    ds_read_b128 v[196:199], v248 offset:16384
    v_mfma_f32_32x32x16_bf16 v[96:111], v[112:115], v[152:155], v[96:111]
    ds_read_b128 v[200:203], v248 offset:20480
    buffer_load_dwordx4 v242, s[24:27], s45 offen offset:2048  lds
    v_mfma_f32_32x32x16_bf16 v[64:79], v[116:119], v[156:159], v[64:79]
    ds_read_b64_tr_b16 v[132:133], v247 offset:20480
    ds_read_b64_tr_b16 v[134:135], v247 offset:21504
    buffer_load_dwordx4 v243, s[24:27], s45 offen offset:3072  lds
    v_mfma_f32_32x32x16_bf16 v[80:95], v[116:119], v[160:163], v[80:95]
    ds_read_b128 v[204:207], v249 offset:12288
    ds_read_b128 v[208:211], v249 offset:16384
    v_mfma_f32_32x32x16_bf16 v[96:111], v[116:119], v[164:167], v[96:111]
    s_add_u32 m0, s48, 0
    s_nop 0
    buffer_load_dwordx4 v244, s[20:23], s46 offen offset:0  lds
    ds_read_b128 v[212:215], v249 offset:20480
    v_mfma_f32_32x32x16_bf16 v[64:79], v[120:123], v[168:171], v[64:79]
    ds_read_b64_tr_b16 v[136:137], v247 offset:24576
    ds_read_b64_tr_b16 v[138:139], v247 offset:25600
    buffer_load_dwordx4 v245, s[20:23], s46 offen offset:1024  lds
    v_mfma_f32_32x32x16_bf16 v[80:95], v[120:123], v[172:175], v[80:95]
    ds_read_b128 v[216:219], v250 offset:12288
    ds_read_b128 v[220:223], v250 offset:16384
    v_mfma_f32_32x32x16_bf16 v[96:111], v[120:123], v[176:179], v[96:111]
    buffer_load_dwordx4 v246, s[20:23], s46 offen offset:2048  lds
    ds_read_b128 v[224:227], v250 offset:20480
    v_mfma_f32_32x32x16_bf16 v[64:79], v[124:127], v[180:183], v[64:79]
    ds_read_b64_tr_b16 v[140:141], v247 offset:28672
    ds_read_b64_tr_b16 v[142:143], v247 offset:29696
    v_mfma_f32_32x32x16_bf16 v[80:95], v[124:127], v[184:187], v[80:95]
    ds_read_b128 v[228:231], v251 offset:12288
    buffer_store_dwordx4 v[252:255], v28, s[36:39], s59 offen offset:1024 sc1
    v_mfma_f32_32x32x16_bf16 v[96:111], v[124:127], v[188:191], v[96:111]
    ds_read_b128 v[232:235], v251 offset:16384
    ds_read_b128 v[236:239], v251 offset:20480
    s_waitcnt vmcnt(17) lgkmcnt(0)
    s_barrier
    s_lshl_b32 s45, s43, 19
    s_mul_i32 s46, s43, 128
    s_add_u32 s46, s46, s56
    s_add_u32 s43, s43, 1
    s_and_b32 s43, s43, 15
    s_add_u32 m0, s47, 16384
    s_nop 0
    buffer_load_dwordx4 v240, s[24:27], s45 offen  lds
    v_mfma_f32_32x32x16_bf16 v[64:79], v[128:131], v[192:195], v[64:79]
    ds_read_b64_tr_b16 v[112:113], v247 offset:32768
    ds_read_b64_tr_b16 v[114:115], v247 offset:33792
    ds_read_b128 v[144:147], v248 offset:24576
    v_mfma_f32_32x32x16_bf16 v[80:95], v[128:131], v[196:199], v[80:95]
    buffer_load_dwordx4 v241, s[24:27], s45 offen offset:1024  lds
    ds_read_b128 v[148:151], v248 offset:28672
    v_mfma_f32_32x32x16_bf16 v[96:111], v[128:131], v[200:203], v[96:111]
    ds_read_b128 v[152:155], v248 offset:32768
    buffer_load_dwordx4 v242, s[24:27], s45 offen offset:2048  lds
    v_mfma_f32_32x32x16_bf16 v[64:79], v[132:135], v[204:207], v[64:79]
    ds_read_b64_tr_b16 v[116:117], v247 offset:36864
    ds_read_b64_tr_b16 v[118:119], v247 offset:37888
    buffer_load_dwordx4 v243, s[24:27], s45 offen offset:3072  lds
    v_mfma_f32_32x32x16_bf16 v[80:95], v[132:135], v[208:211], v[80:95]
    ds_read_b128 v[156:159], v249 offset:24576
    ds_read_b128 v[160:163], v249 offset:28672
    v_mfma_f32_32x32x16_bf16 v[96:111], v[132:135], v[212:215], v[96:111]
    s_add_u32 m0, s48, 12288
    s_nop 0
    buffer_load_dwordx4 v244, s[20:23], s46 offen offset:0  lds
    ds_read_b128 v[164:167], v249 offset:32768
    v_mfma_f32_32x32x16_bf16 v[64:79], v[136:139], v[216:219], v[64:79]
    ds_read_b64_tr_b16 v[120:121], v247 offset:40960
    ds_read_b64_tr_b16 v[122:123], v247 offset:41984
    buffer_load_dwordx4 v245, s[20:23], s46 offen offset:1024  lds
    v_mfma_f32_32x32x16_bf16 v[80:95], v[136:139], v[220:223], v[80:95]
    ds_read_b128 v[168:171], v250 offset:24576
    ds_read_b128 v[172:175], v250 offset:28672
    v_mfma_f32_32x32x16_bf16 v[96:111], v[136:139], v[224:227], v[96:111]
    buffer_load_dwordx4 v246, s[20:23], s46 offen offset:2048  lds
    ds_read_b128 v[176:179], v250 offset:32768
    v_mfma_f32_32x32x16_bf16 v[64:79], v[140:143], v[228:231], v[64:79]
    ds_read_b64_tr_b16 v[124:125], v247 offset:45056
    ds_read_b64_tr_b16 v[126:127], v247 offset:46080
    v_mfma_f32_32x32x16_bf16 v[80:95], v[140:143], v[232:235], v[80:95]
    ds_read_b128 v[180:183], v251 offset:24576
    buffer_store_dwordx4 v[252:255], v28, s[36:39], s81 offen offset:0 sc1
    v_mfma_f32_32x32x16_bf16 v[96:111], v[140:143], v[236:239], v[96:111]
    ds_read_b128 v[184:187], v251 offset:28672
    ds_read_b128 v[188:191], v251 offset:32768
    s_waitcnt vmcnt(17) lgkmcnt(0)
    s_barrier
    s_lshl_b32 s45, s43, 19
    s_mul_i32 s46, s43, 128
    s_add_u32 s46, s46, s56
    s_add_u32 s43, s43, 1
    s_and_b32 s43, s43, 15
    s_add_u32 m0, s47, 32768
    s_nop 0
    buffer_load_dwordx4 v240, s[24:27], s45 offen  lds
    v_mfma_f32_32x32x16_bf16 v[64:79], v[112:115], v[144:147], v[64:79]
    ds_read_b64_tr_b16 v[128:129], v247 offset:49152
    ds_read_b64_tr_b16 v[130:131], v247 offset:50176
    ds_read_b128 v[192:195], v248 offset:36864
    v_mfma_f32_32x32x16_bf16 v[80:95], v[112:115], v[148:151], v[80:95]
    buffer_load_dwordx4 v241, s[24:27], s45 offen offset:1024  lds
    ds_read_b128 v[196:199], v248 offset:40960
    v_mfma_f32_32x32x16_bf16 v[96:111], v[112:115], v[152:155], v[96:111]
    ds_read_b128 v[200:203], v248 offset:45056
    buffer_load_dwordx4 v242, s[24:27], s45 offen offset:2048  lds
    v_mfma_f32_32x32x16_bf16 v[64:79], v[116:119], v[156:159], v[64:79]
    ds_read_b64_tr_b16 v[132:133], v247 offset:53248
    ds_read_b64_tr_b16 v[134:135], v247 offset:54272
    buffer_load_dwordx4 v243, s[24:27], s45 offen offset:3072  lds
    v_mfma_f32_32x32x16_bf16 v[80:95], v[116:119], v[160:163], v[80:95]
    ds_read_b128 v[204:207], v249 offset:36864
    ds_read_b128 v[208:211], v249 offset:40960
    v_mfma_f32_32x32x16_bf16 v[96:111], v[116:119], v[164:167], v[96:111]
    s_add_u32 m0, s48, 24576
    s_nop 0
    buffer_load_dwordx4 v244, s[20:23], s46 offen offset:0  lds
    ds_read_b128 v[212:215], v249 offset:45056
    v_mfma_f32_32x32x16_bf16 v[64:79], v[120:123], v[168:171], v[64:79]
    ds_read_b64_tr_b16 v[136:137], v247 offset:57344
    ds_read_b64_tr_b16 v[138:139], v247 offset:58368
    buffer_load_dwordx4 v245, s[20:23], s46 offen offset:1024  lds
    v_mfma_f32_32x32x16_bf16 v[80:95], v[120:123], v[172:175], v[80:95]
    ds_read_b128 v[216:219], v250 offset:36864
    ds_read_b128 v[220:223], v250 offset:40960
    v_mfma_f32_32x32x16_bf16 v[96:111], v[120:123], v[176:179], v[96:111]
    buffer_load_dwordx4 v246, s[20:23], s46 offen offset:2048  lds
    ds_read_b128 v[224:227], v250 offset:45056
    v_mfma_f32_32x32x16_bf16 v[64:79], v[124:127], v[180:183], v[64:79]
    ds_read_b64_tr_b16 v[140:141], v247 offset:61440
    ds_read_b64_tr_b16 v[142:143], v247 offset:62464
    v_mfma_f32_32x32x16_bf16 v[80:95], v[124:127], v[184:187], v[80:95]
    ds_read_b128 v[228:231], v251 offset:36864
    buffer_store_dwordx4 v[252:255], v28, s[36:39], s81 offen offset:1024 sc1
    v_mfma_f32_32x32x16_bf16 v[96:111], v[124:127], v[188:191], v[96:111]
    ds_read_b128 v[232:235], v251 offset:40960
    ds_read_b128 v[236:239], v251 offset:45056
    s_waitcnt vmcnt(17) lgkmcnt(0)
    s_barrier
    s_lshl_b32 s45, s43, 19
    s_mul_i32 s46, s43, 128
    s_add_u32 s46, s46, s56
    s_add_u32 s43, s43, 1
    s_and_b32 s43, s43, 15
    s_add_u32 m0, s47, 49152
    s_nop 0
    buffer_load_dwordx4 v240, s[24:27], s45 offen  lds
    v_mfma_f32_32x32x16_bf16 v[64:79], v[128:131], v[192:195], v[64:79]
    ds_read_b64_tr_b16 v[112:113], v247 offset:0
    ds_read_b64_tr_b16 v[114:115], v247 offset:1024
    ds_read_b128 v[144:147], v248 offset:0
    v_mfma_f32_32x32x16_bf16 v[80:95], v[128:131], v[196:199], v[80:95]
    buffer_load_dwordx4 v241, s[24:27], s45 offen offset:1024  lds
    ds_read_b128 v[148:151], v248 offset:4096
    v_mfma_f32_32x32x16_bf16 v[96:111], v[128:131], v[200:203], v[96:111]
    ds_read_b128 v[152:155], v248 offset:8192
    buffer_load_dwordx4 v242, s[24:27], s45 offen offset:2048  lds
    v_mfma_f32_32x32x16_bf16 v[64:79], v[132:135], v[204:207], v[64:79]
    ds_read_b64_tr_b16 v[116:117], v247 offset:4096
    ds_read_b64_tr_b16 v[118:119], v247 offset:5120
    buffer_load_dwordx4 v243, s[24:27], s45 offen offset:3072  lds
    v_mfma_f32_32x32x16_bf16 v[80:95], v[132:135], v[208:211], v[80:95]
    ds_read_b128 v[156:159], v249 offset:0
    ds_read_b128 v[160:163], v249 offset:4096
    v_mfma_f32_32x32x16_bf16 v[96:111], v[132:135], v[212:215], v[96:111]
    s_add_u32 m0, s48, 36864
    s_nop 0
    buffer_load_dwordx4 v244, s[20:23], s46 offen offset:0  lds
    ds_read_b128 v[164:167], v249 offset:8192
    v_mfma_f32_32x32x16_bf16 v[64:79], v[136:139], v[216:219], v[64:79]
    ds_read_b64_tr_b16 v[120:121], v247 offset:8192
    ds_read_b64_tr_b16 v[122:123], v247 offset:9216
    buffer_load_dwordx4 v245, s[20:23], s46 offen offset:1024  lds
    v_mfma_f32_32x32x16_bf16 v[80:95], v[136:139], v[220:223], v[80:95]
    ds_read_b128 v[168:171], v250 offset:0
    ds_read_b128 v[172:175], v250 offset:4096
    v_mfma_f32_32x32x16_bf16 v[96:111], v[136:139], v[224:227], v[96:111]
    buffer_load_dwordx4 v246, s[20:23], s46 offen offset:2048  lds
    ds_read_b128 v[176:179], v250 offset:8192
    v_mfma_f32_32x32x16_bf16 v[64:79], v[140:143], v[228:231], v[64:79]
    ds_read_b64_tr_b16 v[124:125], v247 offset:12288
    ds_read_b64_tr_b16 v[126:127], v247 offset:13312
    v_mfma_f32_32x32x16_bf16 v[80:95], v[140:143], v[232:235], v[80:95]
    ds_read_b128 v[180:183], v251 offset:0
    buffer_store_dwordx4 v[252:255], v21, s[36:39], s80 offen sc1
    v_mfma_f32_32x32x16_bf16 v[96:111], v[140:143], v[236:239], v[96:111]
    ds_read_b128 v[184:187], v251 offset:4096
    ds_read_b128 v[188:191], v251 offset:8192
    s_waitcnt vmcnt(17) lgkmcnt(0)
    s_barrier
    s_lshl_b32 s45, s43, 19
    s_mul_i32 s46, s43, 128
    s_add_u32 s46, s46, s56
    s_add_u32 s43, s43, 1
    s_and_b32 s43, s43, 15
    s_add_u32 m0, s47, 0
    s_nop 0
    buffer_load_dwordx4 v240, s[24:27], s45 offen  lds
    v_mfma_f32_32x32x16_bf16 v[64:79], v[112:115], v[144:147], v[64:79]
    ds_read_b64_tr_b16 v[128:129], v247 offset:16384
    ds_read_b64_tr_b16 v[130:131], v247 offset:17408
    ds_read_b128 v[192:195], v248 offset:12288
    v_mfma_f32_32x32x16_bf16 v[80:95], v[112:115], v[148:151], v[80:95]
    buffer_load_dwordx4 v241, s[24:27], s45 offen offset:1024  lds
    ds_read_b128 v[196:199], v248 offset:16384
    v_mfma_f32_32x32x16_bf16 v[96:111], v[112:115], v[152:155], v[96:111]
    ds_read_b128 v[200:203], v248 offset:20480
    buffer_load_dwordx4 v242, s[24:27], s45 offen offset:2048  lds
    v_mfma_f32_32x32x16_bf16 v[64:79], v[116:119], v[156:159], v[64:79]
    ds_read_b64_tr_b16 v[132:133], v247 offset:20480
    ds_read_b64_tr_b16 v[134:135], v247 offset:21504
    buffer_load_dwordx4 v243, s[24:27], s45 offen offset:3072  lds
    v_mfma_f32_32x32x16_bf16 v[80:95], v[116:119], v[160:163], v[80:95]
    ds_read_b128 v[204:207], v249 offset:12288
    ds_read_b128 v[208:211], v249 offset:16384
    v_mfma_f32_32x32x16_bf16 v[96:111], v[116:119], v[164:167], v[96:111]
    s_add_u32 m0, s48, 0
    s_nop 0
    buffer_load_dwordx4 v244, s[20:23], s46 offen offset:0  lds
    ds_read_b128 v[212:215], v249 offset:20480
    v_mfma_f32_32x32x16_bf16 v[64:79], v[120:123], v[168:171], v[64:79]
    ds_read_b64_tr_b16 v[136:137], v247 offset:24576
    ds_read_b64_tr_b16 v[138:139], v247 offset:25600
    buffer_load_dwordx4 v245, s[20:23], s46 offen offset:1024  lds
    v_mfma_f32_32x32x16_bf16 v[80:95], v[120:123], v[172:175], v[80:95]
    ds_read_b128 v[216:219], v250 offset:12288
    ds_read_b128 v[220:223], v250 offset:16384
    v_mfma_f32_32x32x16_bf16 v[96:111], v[120:123], v[176:179], v[96:111]
    buffer_load_dwordx4 v246, s[20:23], s46 offen offset:2048  lds
    ds_read_b128 v[224:227], v250 offset:20480
    v_mfma_f32_32x32x16_bf16 v[64:79], v[124:127], v[180:183], v[64:79]
    ds_read_b64_tr_b16 v[140:141], v247 offset:28672
    ds_read_b64_tr_b16 v[142:143], v247 offset:29696
    v_mfma_f32_32x32x16_bf16 v[80:95], v[124:127], v[184:187], v[80:95]
    ds_read_b128 v[228:231], v251 offset:12288
    buffer_store_dwordx4 v[252:255], v21, s[36:39], s97 offen sc1
    v_mfma_f32_32x32x16_bf16 v[96:111], v[124:127], v[188:191], v[96:111]
    ds_read_b128 v[232:235], v251 offset:16384
    ds_read_b128 v[236:239], v251 offset:20480
    s_waitcnt vmcnt(17) lgkmcnt(0)
    s_barrier
    s_lshl_b32 s45, s43, 19
    s_mul_i32 s46, s43, 128
    s_add_u32 s46, s46, s56
    s_add_u32 s43, s43, 1
    s_and_b32 s43, s43, 15
    s_add_u32 m0, s47, 16384
    s_nop 0
    buffer_load_dwordx4 v240, s[24:27], s45 offen  lds
    v_mfma_f32_32x32x16_bf16 v[64:79], v[128:131], v[192:195], v[64:79]
    ds_read_b64_tr_b16 v[112:113], v247 offset:32768
    ds_read_b64_tr_b16 v[114:115], v247 offset:33792
    ds_read_b128 v[144:147], v248 offset:24576
    v_mfma_f32_32x32x16_bf16 v[80:95], v[128:131], v[196:199], v[80:95]
    buffer_load_dwordx4 v241, s[24:27], s45 offen offset:1024  lds
    ds_read_b128 v[148:151], v248 offset:28672
    v_mfma_f32_32x32x16_bf16 v[96:111], v[128:131], v[200:203], v[96:111]
    ds_read_b128 v[152:155], v248 offset:32768
    buffer_load_dwordx4 v242, s[24:27], s45 offen offset:2048  lds
    v_mfma_f32_32x32x16_bf16 v[64:79], v[132:135], v[204:207], v[64:79]
    ds_read_b64_tr_b16 v[116:117], v247 offset:36864
    ds_read_b64_tr_b16 v[118:119], v247 offset:37888
    buffer_load_dwordx4 v243, s[24:27], s45 offen offset:3072  lds
    v_mfma_f32_32x32x16_bf16 v[80:95], v[132:135], v[208:211], v[80:95]
    ds_read_b128 v[156:159], v249 offset:24576
    ds_read_b128 v[160:163], v249 offset:28672
    v_mfma_f32_32x32x16_bf16 v[96:111], v[132:135], v[212:215], v[96:111]
    s_add_u32 m0, s48, 12288
    s_nop 0
    buffer_load_dwordx4 v244, s[20:23], s46 offen offset:0  lds
    ds_read_b128 v[164:167], v249 offset:32768
    v_mfma_f32_32x32x16_bf16 v[64:79], v[136:139], v[216:219], v[64:79]
    ds_read_b64_tr_b16 v[120:121], v247 offset:40960
    ds_read_b64_tr_b16 v[122:123], v247 offset:41984
    buffer_load_dwordx4 v245, s[20:23], s46 offen offset:1024  lds
    v_mfma_f32_32x32x16_bf16 v[80:95], v[136:139], v[220:223], v[80:95]
    ds_read_b128 v[168:171], v250 offset:24576
    ds_read_b128 v[172:175], v250 offset:28672
    v_mfma_f32_32x32x16_bf16 v[96:111], v[136:139], v[224:227], v[96:111]
    buffer_load_dwordx4 v246, s[20:23], s46 offen offset:2048  lds
    ds_read_b128 v[176:179], v250 offset:32768
    v_mfma_f32_32x32x16_bf16 v[64:79], v[140:143], v[228:231], v[64:79]
    ds_read_b64_tr_b16 v[124:125], v247 offset:45056
    ds_read_b64_tr_b16 v[126:127], v247 offset:46080
    v_mfma_f32_32x32x16_bf16 v[80:95], v[140:143], v[232:235], v[80:95]
    ds_read_b128 v[180:183], v251 offset:24576
    buffer_store_dwordx4 v[252:255], v21, s[36:39], s98 offen sc1
    v_mfma_f32_32x32x16_bf16 v[96:111], v[140:143], v[236:239], v[96:111]
    ds_read_b128 v[184:187], v251 offset:28672
    ds_read_b128 v[188:191], v251 offset:32768
    s_waitcnt vmcnt(17) lgkmcnt(0)
    s_barrier
    s_lshl_b32 s45, s43, 19
    s_mul_i32 s46, s43, 128
    s_add_u32 s46, s46, s56
    s_add_u32 s43, s43, 1
    s_and_b32 s43, s43, 15
    s_add_u32 m0, s47, 32768
    s_nop 0
    buffer_load_dwordx4 v240, s[24:27], s45 offen  lds
    v_mfma_f32_32x32x16_bf16 v[64:79], v[112:115], v[144:147], v[64:79]
    ds_read_b64_tr_b16 v[128:129], v247 offset:49152
    ds_read_b64_tr_b16 v[130:131], v247 offset:50176
    ds_read_b128 v[192:195], v248 offset:36864
    v_mfma_f32_32x32x16_bf16 v[80:95], v[112:115], v[148:151], v[80:95]
    buffer_load_dwordx4 v241, s[24:27], s45 offen offset:1024  lds
    ds_read_b128 v[196:199], v248 offset:40960
    v_mfma_f32_32x32x16_bf16 v[96:111], v[112:115], v[152:155], v[96:111]
    ds_read_b128 v[200:203], v248 offset:45056
    buffer_load_dwordx4 v242, s[24:27], s45 offen offset:2048  lds
    v_mfma_f32_32x32x16_bf16 v[64:79], v[116:119], v[156:159], v[64:79]
    ds_read_b64_tr_b16 v[132:133], v247 offset:53248
    ds_read_b64_tr_b16 v[134:135], v247 offset:54272
    v_mfma_f32_32x32x16_bf16 v[80:95], v[116:119], v[160:163], v[80:95]
    ds_read_b128 v[204:207], v249 offset:36864
    buffer_load_dwordx4 v243, s[24:27], s45 offen offset:3072  lds
    ds_read_b128 v[208:211], v249 offset:40960
    v_mfma_f32_32x32x16_bf16 v[96:111], v[116:119], v[164:167], v[96:111]
    ds_read_b128 v[212:215], v249 offset:45056
    s_add_u32 m0, s48, 24576
    s_nop 0
    buffer_load_dwordx4 v244, s[20:23], s46 offen offset:0  lds
    v_mfma_f32_32x32x16_bf16 v[64:79], v[120:123], v[168:171], v[64:79]
    ds_read_b64_tr_b16 v[136:137], v247 offset:57344
    ds_read_b64_tr_b16 v[138:139], v247 offset:58368
    v_mfma_f32_32x32x16_bf16 v[80:95], v[120:123], v[172:175], v[80:95]
    ds_read_b128 v[216:219], v250 offset:36864
    buffer_load_dwordx4 v245, s[20:23], s46 offen offset:1024  lds
    v_mfma_f32_32x32x16_bf16 v[96:111], v[120:123], v[176:179], v[96:111]
    ds_read_b128 v[220:223], v250 offset:40960
    ds_read_b128 v[224:227], v250 offset:45056
    buffer_load_dwordx4 v246, s[20:23], s46 offen offset:2048  lds
    v_mfma_f32_32x32x16_bf16 v[64:79], v[124:127], v[180:183], v[64:79]
    ds_read_b64_tr_b16 v[140:141], v247 offset:61440
    ds_read_b64_tr_b16 v[142:143], v247 offset:62464
    v_mfma_f32_32x32x16_bf16 v[80:95], v[124:127], v[184:187], v[80:95]
    ds_read_b128 v[228:231], v251 offset:36864
    v_mfma_f32_32x32x16_bf16 v[96:111], v[124:127], v[188:191], v[96:111]
    ds_read_b128 v[232:235], v251 offset:40960
    ds_read_b128 v[236:239], v251 offset:45056
    s_waitcnt vmcnt(16) lgkmcnt(0)
    s_barrier
    s_lshl_b32 s45, s43, 19
    s_mul_i32 s46, s43, 128
    s_add_u32 s46, s46, s56
    s_add_u32 s43, s43, 1
    s_and_b32 s43, s43, 15
    s_add_u32 m0, s47, 49152
    s_nop 0
    buffer_load_dwordx4 v240, s[24:27], s45 offen  lds
    v_mfma_f32_32x32x16_bf16 v[64:79], v[128:131], v[192:195], v[64:79]
    ds_read_b64_tr_b16 v[112:113], v247 offset:0
    ds_read_b64_tr_b16 v[114:115], v247 offset:1024
    buffer_load_dwordx4 v241, s[24:27], s45 offen offset:1024  lds
    ds_read_b128 v[144:147], v248 offset:0
    v_mfma_f32_32x32x16_bf16 v[80:95], v[128:131], v[196:199], v[80:95]
    buffer_load_dwordx4 v242, s[24:27], s45 offen offset:2048  lds
    ds_read_b128 v[148:151], v248 offset:4096
    buffer_load_dwordx4 v243, s[24:27], s45 offen offset:3072  lds
    v_mfma_f32_32x32x16_bf16 v[96:111], v[128:131], v[200:203], v[96:111]
    ds_read_b128 v[152:155], v248 offset:8192
    s_add_u32 m0, s48, 36864
    s_nop 0
    buffer_load_dwordx4 v244, s[20:23], s46 offen offset:0  lds
    ds_read_b64_tr_b16 v[116:117], v247 offset:4096
    v_mfma_f32_32x32x16_bf16 v[64:79], v[132:135], v[204:207], v[64:79]
    buffer_load_dwordx4 v245, s[20:23], s46 offen offset:1024  lds
    ds_read_b64_tr_b16 v[118:119], v247 offset:5120
    buffer_load_dwordx4 v246, s[20:23], s46 offen offset:2048  lds
    v_mfma_f32_32x32x16_bf16 v[80:95], v[132:135], v[208:211], v[80:95]
    ds_read_b128 v[156:159], v249 offset:0
    ds_read_b128 v[160:163], v249 offset:4096
    v_mfma_f32_32x32x16_bf16 v[96:111], v[132:135], v[212:215], v[96:111]
    s_mov_b32 s49, 0
    s_add_u32 m0, s47, 114688
    s_nop 0
    buffer_load_dwordx4 v3, s[32:35], s49 offen offset:0 nt lds
    ds_read_b128 v[164:167], v249 offset:8192
    buffer_load_dwordx4 v3, s[32:35], s49 offen offset:1024 nt lds
    v_mfma_f32_32x32x16_bf16 v[64:79], v[136:139], v[216:219], v[64:79]
    ds_read_b64_tr_b16 v[120:121], v247 offset:8192
    ds_read_b64_tr_b16 v[122:123], v247 offset:9216
    buffer_load_dwordx4 v3, s[32:35], s49 offen offset:2048 nt lds
    v_mfma_f32_32x32x16_bf16 v[80:95], v[136:139], v[220:223], v[80:95]
    ds_read_b128 v[168:171], v250 offset:0
    buffer_load_dwordx4 v3, s[32:35], s49 offen offset:3072 nt lds
    ds_read_b128 v[172:175], v250 offset:4096
    v_mfma_f32_32x32x16_bf16 v[96:111], v[136:139], v[224:227], v[96:111]
    ds_read_b128 v[176:179], v250 offset:8192
    s_mov_b32 s49, 16384
    s_add_u32 m0, s47, 131072
    s_nop 0
    buffer_load_dwordx4 v3, s[32:35], s49 offen offset:0 nt lds
    v_mfma_f32_32x32x16_bf16 v[64:79], v[140:143], v[228:231], v[64:79]
    ds_read_b64_tr_b16 v[124:125], v247 offset:12288
    buffer_load_dwordx4 v3, s[32:35], s49 offen offset:1024 nt lds
    ds_read_b64_tr_b16 v[126:127], v247 offset:13312
    v_mfma_f32_32x32x16_bf16 v[80:95], v[140:143], v[232:235], v[80:95]
    buffer_load_dwordx4 v3, s[32:35], s49 offen offset:2048 nt lds
    ds_read_b128 v[180:183], v251 offset:0
    buffer_load_dwordx4 v3, s[32:35], s49 offen offset:3072 nt lds
    v_mfma_f32_32x32x16_bf16 v[96:111], v[140:143], v[236:239], v[96:111]
    ds_read_b128 v[184:187], v251 offset:4096
    ds_read_b128 v[188:191], v251 offset:8192
    s_waitcnt vmcnt(23) lgkmcnt(0)
    s_barrier
    s_mov_b32 s49, 32768
    s_add_u32 m0, s47, 147456
    s_nop 0
    buffer_load_dwordx4 v3, s[32:35], s49 offen offset:0 nt lds
    v_mfma_f32_32x32x16_bf16 v[64:79], v[112:115], v[144:147], v[64:79]
    ds_read_b64_tr_b16 v[128:129], v247 offset:16384
    ds_read_b64_tr_b16 v[130:131], v247 offset:17408
    v_mfma_f32_32x32x16_bf16 v[80:95], v[112:115], v[148:151], v[80:95]
    ds_read_b128 v[192:195], v248 offset:12288
    ds_read_b128 v[196:199], v248 offset:16384
    v_mfma_f32_32x32x16_bf16 v[96:111], v[112:115], v[152:155], v[96:111]
    buffer_load_dwordx4 v3, s[32:35], s49 offen offset:1024 nt lds
    ds_read_b128 v[200:203], v248 offset:20480
    v_mfma_f32_32x32x16_bf16 v[64:79], v[116:119], v[156:159], v[64:79]
    ds_read_b64_tr_b16 v[132:133], v247 offset:20480
    ds_read_b64_tr_b16 v[134:135], v247 offset:21504
    v_mfma_f32_32x32x16_bf16 v[80:95], v[116:119], v[160:163], v[80:95]
    ds_read_b128 v[204:207], v249 offset:12288
    buffer_load_dwordx4 v3, s[32:35], s49 offen offset:2048 nt lds
    v_mfma_f32_32x32x16_bf16 v[96:111], v[116:119], v[164:167], v[96:111]
    ds_read_b128 v[208:211], v249 offset:16384
    ds_read_b128 v[212:215], v249 offset:20480
    v_mfma_f32_32x32x16_bf16 v[64:79], v[120:123], v[168:171], v[64:79]
    ds_read_b64_tr_b16 v[136:137], v247 offset:24576
    ds_read_b64_tr_b16 v[138:139], v247 offset:25600
    v_mfma_f32_32x32x16_bf16 v[80:95], v[120:123], v[172:175], v[80:95]
    buffer_load_dwordx4 v3, s[32:35], s49 offen offset:3072 nt lds
    ds_read_b128 v[216:219], v250 offset:12288
    v_mfma_f32_32x32x16_bf16 v[96:111], v[120:123], v[176:179], v[96:111]
    ds_read_b128 v[220:223], v250 offset:16384
    ds_read_b128 v[224:227], v250 offset:20480
    v_mfma_f32_32x32x16_bf16 v[64:79], v[124:127], v[180:183], v[64:79]
    ds_read_b64_tr_b16 v[140:141], v247 offset:28672
    v_mfma_f32_32x32x16_bf16 v[80:95], v[124:127], v[184:187], v[80:95]
    ds_read_b64_tr_b16 v[142:143], v247 offset:29696
    ds_read_b128 v[228:231], v251 offset:12288
    v_mfma_f32_32x32x16_bf16 v[96:111], v[124:127], v[188:191], v[96:111]
    ds_read_b128 v[232:235], v251 offset:16384
    ds_read_b128 v[236:239], v251 offset:20480
    s_waitcnt vmcnt(19) lgkmcnt(0)
    s_barrier
    s_cmp_lg_u32 s40, 0
    s_cbranch_scc1 L_noarr
    s_mov_b64 exec, 1
    buffer_atomic_add v29, off, s[76:79], s83 sc1
    s_mov_b64 exec, -1
L_noarr:
    s_nop 4
    v_mfma_f32_32x32x16_bf16 v[64:79], v[128:131], v[192:195], v[64:79]
    ds_read_b64_tr_b16 v[112:113], v247 offset:32768
    ds_read_b64_tr_b16 v[114:115], v247 offset:33792
    ds_read_b128 v[144:147], v248 offset:24576
    v_mfma_f32_32x32x16_bf16 v[80:95], v[128:131], v[196:199], v[80:95]
    ds_read_b128 v[148:151], v248 offset:28672
    s_mov_b32 s49, 49152
    s_add_u32 m0, s47, 65536
    s_nop 0
    buffer_load_dwordx4 v3, s[32:35], s49 offen offset:0 nt lds
    v_mfma_f32_32x32x16_bf16 v[96:111], v[128:131], v[200:203], v[96:111]
    ds_read_b128 v[152:155], v248 offset:32768
    ds_read_b64_tr_b16 v[116:117], v247 offset:36864
    v_mfma_f32_32x32x16_bf16 v[64:79], v[132:135], v[204:207], v[64:79]
    ds_read_b64_tr_b16 v[118:119], v247 offset:37888
    buffer_load_dwordx4 v3, s[32:35], s49 offen offset:1024 nt lds
    v_mfma_f32_32x32x16_bf16 v[80:95], v[132:135], v[208:211], v[80:95]
    ds_read_b128 v[156:159], v249 offset:24576
    ds_read_b128 v[160:163], v249 offset:28672
    v_mfma_f32_32x32x16_bf16 v[96:111], v[132:135], v[212:215], v[96:111]
    ds_read_b128 v[164:167], v249 offset:32768
    buffer_load_dwordx4 v3, s[32:35], s49 offen offset:2048 nt lds
    v_mfma_f32_32x32x16_bf16 v[64:79], v[136:139], v[216:219], v[64:79]
    ds_read_b64_tr_b16 v[120:121], v247 offset:40960
    ds_read_b64_tr_b16 v[122:123], v247 offset:41984
    v_mfma_f32_32x32x16_bf16 v[80:95], v[136:139], v[220:223], v[80:95]
    ds_read_b128 v[168:171], v250 offset:24576
    ds_read_b128 v[172:175], v250 offset:28672
    v_mfma_f32_32x32x16_bf16 v[96:111], v[136:139], v[224:227], v[96:111]
    buffer_load_dwordx4 v3, s[32:35], s49 offen offset:3072 nt lds
    ds_read_b128 v[176:179], v250 offset:32768
    v_mfma_f32_32x32x16_bf16 v[64:79], v[140:143], v[228:231], v[64:79]
    ds_read_b64_tr_b16 v[124:125], v247 offset:45056
    ds_read_b64_tr_b16 v[126:127], v247 offset:46080
    v_mfma_f32_32x32x16_bf16 v[80:95], v[140:143], v[232:235], v[80:95]
    ds_read_b128 v[180:183], v251 offset:24576
    v_mfma_f32_32x32x16_bf16 v[96:111], v[140:143], v[236:239], v[96:111]
    ds_read_b128 v[184:187], v251 offset:28672
    ds_read_b128 v[188:191], v251 offset:32768
    s_waitcnt vmcnt(16) lgkmcnt(0)
    s_barrier
    ds_read_b64_tr_b16 v[128:129], v247 offset:49152
    v_mfma_f32_32x32x16_bf16 v[64:79], v[112:115], v[144:147], v[64:79]
    ds_read_b64_tr_b16 v[130:131], v247 offset:50176
    ds_read_b128 v[192:195], v248 offset:36864
    v_mfma_f32_32x32x16_bf16 v[80:95], v[112:115], v[148:151], v[80:95]
    ds_read_b128 v[196:199], v248 offset:40960
    ds_read_b128 v[200:203], v248 offset:45056
    v_mfma_f32_32x32x16_bf16 v[96:111], v[112:115], v[152:155], v[96:111]
    ds_read_b64_tr_b16 v[132:133], v247 offset:53248
    v_mfma_f32_32x32x16_bf16 v[64:79], v[116:119], v[156:159], v[64:79]
    ds_read_b64_tr_b16 v[134:135], v247 offset:54272
    ds_read_b128 v[204:207], v249 offset:36864
    v_mfma_f32_32x32x16_bf16 v[80:95], v[116:119], v[160:163], v[80:95]
    ds_read_b128 v[208:211], v249 offset:40960
    v_mfma_f32_32x32x16_bf16 v[96:111], v[116:119], v[164:167], v[96:111]
    ds_read_b128 v[212:215], v249 offset:45056
    ds_read_b64_tr_b16 v[136:137], v247 offset:57344
    v_mfma_f32_32x32x16_bf16 v[64:79], v[120:123], v[168:171], v[64:79]
    ds_read_b64_tr_b16 v[138:139], v247 offset:58368
    ds_read_b128 v[216:219], v250 offset:36864
    v_mfma_f32_32x32x16_bf16 v[80:95], v[120:123], v[172:175], v[80:95]
    ds_read_b128 v[220:223], v250 offset:40960
    v_mfma_f32_32x32x16_bf16 v[96:111], v[120:123], v[176:179], v[96:111]
    ds_read_b128 v[224:227], v250 offset:45056
    ds_read_b64_tr_b16 v[140:141], v247 offset:61440
    v_mfma_f32_32x32x16_bf16 v[64:79], v[124:127], v[180:183], v[64:79]
    ds_read_b64_tr_b16 v[142:143], v247 offset:62464
    v_mfma_f32_32x32x16_bf16 v[80:95], v[124:127], v[184:187], v[80:95]
    ds_read_b128 v[228:231], v251 offset:36864
    ds_read_b128 v[232:235], v251 offset:40960
    v_mfma_f32_32x32x16_bf16 v[96:111], v[124:127], v[188:191], v[96:111]
    ds_read_b128 v[236:239], v251 offset:45056
    s_waitcnt lgkmcnt(0)
    s_barrier
    s_mov_b32 s49, 65536
    s_add_u32 m0, s47, 81920
    s_nop 0
    buffer_load_dwordx4 v3, s[32:35], s49 offen offset:0 nt lds
    v_mfma_f32_32x32x16_bf16 v[64:79], v[128:131], v[192:195], v[64:79]
    buffer_load_dwordx4 v3, s[32:35], s49 offen offset:1024 nt lds
    v_mfma_f32_32x32x16_bf16 v[80:95], v[128:131], v[196:199], v[80:95]
    v_mfma_f32_32x32x16_bf16 v[96:111], v[128:131], v[200:203], v[96:111]
    v_mfma_f32_32x32x16_bf16 v[64:79], v[132:135], v[204:207], v[64:79]
    buffer_load_dwordx4 v3, s[32:35], s49 offen offset:2048 nt lds
    v_mfma_f32_32x32x16_bf16 v[80:95], v[132:135], v[208:211], v[80:95]
    v_mfma_f32_32x32x16_bf16 v[96:111], v[132:135], v[212:215], v[96:111]
    v_mfma_f32_32x32x16_bf16 v[64:79], v[136:139], v[216:219], v[64:79]
    buffer_load_dwordx4 v3, s[32:35], s49 offen offset:3072 nt lds
    v_mfma_f32_32x32x16_bf16 v[80:95], v[136:139], v[220:223], v[80:95]
    v_mfma_f32_32x32x16_bf16 v[96:111], v[136:139], v[224:227], v[96:111]
    v_mfma_f32_32x32x16_bf16 v[64:79], v[140:143], v[228:231], v[64:79]
    v_mfma_f32_32x32x16_bf16 v[80:95], v[140:143], v[232:235], v[80:95]
    v_mfma_f32_32x32x16_bf16 v[96:111], v[140:143], v[236:239], v[96:111]
    s_nop 9
    v_cvt_pk_bf16_f32 v64, v64, v65
    v_cvt_pk_bf16_f32 v65, v66, v67
    v_cvt_pk_bf16_f32 v66, v68, v69
    v_cvt_pk_bf16_f32 v67, v70, v71
    v_cvt_pk_bf16_f32 v68, v72, v73
    v_cvt_pk_bf16_f32 v69, v74, v75
    v_cvt_pk_bf16_f32 v70, v76, v77
    v_cvt_pk_bf16_f32 v71, v78, v79
    ds_write_b128 v28, v[64:67] offset:0
    ds_write_b128 v28, v[68:71] offset:1024
    v_cvt_pk_bf16_f32 v80, v80, v81
    v_cvt_pk_bf16_f32 v81, v82, v83
    v_cvt_pk_bf16_f32 v82, v84, v85
    v_cvt_pk_bf16_f32 v83, v86, v87
    v_cvt_pk_bf16_f32 v84, v88, v89
    v_cvt_pk_bf16_f32 v85, v90, v91
    v_cvt_pk_bf16_f32 v86, v92, v93
    v_cvt_pk_bf16_f32 v87, v94, v95
    ds_write_b128 v28, v[80:83] offset:8192
    ds_write_b128 v28, v[84:87] offset:9216
    v_cvt_pk_bf16_f32 v96, v96, v97
    v_cvt_pk_bf16_f32 v97, v98, v99
    v_cvt_pk_bf16_f32 v98, v100, v101
    v_cvt_pk_bf16_f32 v99, v102, v103
    v_cvt_pk_bf16_f32 v100, v104, v105
    v_cvt_pk_bf16_f32 v101, v106, v107
    v_cvt_pk_bf16_f32 v102, v108, v109
    v_cvt_pk_bf16_f32 v103, v110, v111
    ds_write_b128 v28, v[96:99] offset:16384
    ds_write_b128 v28, v[100:103] offset:17408
    v_add_u32 v4, 0, v57
    v_add_u32 v5, 15360, v57
    v_add_u32 v6, 30720, v57
    v_add_u32 v7, 46080, v57
    v_add_u32 v9, 0, v56
    v_xor_b32 v10, 64, v9
    v_add_u32 v11, 65536, v56
    v_xor_b32 v12, 64, v11
    v_add_u32 v13, 131072, v56
    v_xor_b32 v14, 64, v13
    v_add_u32 v15, 114688, v22
    v_add_u32 v16, 114688, v21
    v_add_u32 v17, 65536, v22
    v_add_u32 v18, 65536, v21
    s_waitcnt lgkmcnt(0)
    s_barrier
    ds_read_b128 a[128:131], v21 offset:0
    ds_read_b128 a[132:135], v21 offset:1024
    ds_read_b128 a[136:139], v21 offset:2048
    ds_read_b128 a[140:143], v21 offset:3072
    ds_read_b128 a[144:147], v21 offset:4096
    ds_read_b128 a[148:151], v21 offset:5120
    ds_read_b128 a[152:155], v21 offset:6144
    ds_read_b128 a[156:159], v21 offset:7168
    ds_read_b128 a[160:163], v21 offset:8192
    ds_read_b128 a[164:167], v21 offset:9216
    ds_read_b128 a[168:171], v21 offset:10240
    ds_read_b128 a[172:175], v21 offset:11264
    ds_read_b128 a[176:179], v21 offset:12288
    ds_read_b128 a[180:183], v21 offset:13312
    ds_read_b128 a[184:187], v21 offset:14336
    ds_read_b128 a[188:191], v21 offset:15360
    ds_read_b128 a[192:195], v21 offset:16384
    ds_read_b128 a[196:199], v21 offset:17408
    ds_read_b128 a[200:203], v21 offset:18432
    ds_read_b128 a[204:207], v21 offset:19456
    ds_read_b128 a[208:211], v21 offset:20480
    ds_read_b128 a[212:215], v21 offset:21504
    ds_read_b128 a[216:219], v21 offset:22528
    ds_read_b128 a[220:223], v21 offset:23552
    s_waitcnt lgkmcnt(15)
    v_mfma_f32_32x32x16_bf16 v[64:79], a[0:3], a[128:131], 0
    s_mov_b32 s49, 81920
    s_add_u32 m0, s47, 32768
    s_nop 0
    buffer_load_dwordx4 v3, s[32:35], s49 offen offset:0 nt lds
    v_mfma_f32_32x32x16_bf16 v[80:95], a[32:35], a[128:131], 0
    v_mfma_f32_32x32x16_bf16 v[64:79], a[4:7], a[132:135], v[64:79]
    v_mfma_f32_32x32x16_bf16 v[80:95], a[36:39], a[132:135], v[80:95]
    buffer_load_dwordx4 v3, s[32:35], s49 offen offset:1024 nt lds
    v_mfma_f32_32x32x16_bf16 v[64:79], a[8:11], a[136:139], v[64:79]
    v_mfma_f32_32x32x16_bf16 v[80:95], a[40:43], a[136:139], v[80:95]
    v_mfma_f32_32x32x16_bf16 v[64:79], a[12:15], a[140:143], v[64:79]
    v_mfma_f32_32x32x16_bf16 v[80:95], a[44:47], a[140:143], v[80:95]
    buffer_load_dwordx4 v3, s[32:35], s49 offen offset:2048 nt lds
    v_mfma_f32_32x32x16_bf16 v[64:79], a[16:19], a[144:147], v[64:79]
    v_mfma_f32_32x32x16_bf16 v[80:95], a[48:51], a[144:147], v[80:95]
    v_mfma_f32_32x32x16_bf16 v[64:79], a[20:23], a[148:151], v[64:79]
    buffer_load_dwordx4 v3, s[32:35], s49 offen offset:3072 nt lds
    v_mfma_f32_32x32x16_bf16 v[80:95], a[52:55], a[148:151], v[80:95]
    v_mfma_f32_32x32x16_bf16 v[64:79], a[24:27], a[152:155], v[64:79]
    v_mfma_f32_32x32x16_bf16 v[80:95], a[56:59], a[152:155], v[80:95]
    v_mfma_f32_32x32x16_bf16 v[64:79], a[28:31], a[156:159], v[64:79]
    v_mfma_f32_32x32x16_bf16 v[80:95], a[60:63], a[156:159], v[80:95]
    v_mfma_f32_32x32x16_bf16 v[96:111], a[64:67], a[128:131], 0
    v_mfma_f32_32x32x16_bf16 v[112:127], a[96:99], a[128:131], 0
    v_mfma_f32_32x32x16_bf16 v[96:111], a[68:71], a[132:135], v[96:111]
    s_nop 7
    v_max_f32 v25, v64, v65
    v_max3_f32 v25, v66, v67, v25
    v_mfma_f32_32x32x16_bf16 v[112:127], a[100:103], a[132:135], v[112:127]
    v_max3_f32 v25, v68, v69, v25
    v_mfma_f32_32x32x16_bf16 v[96:111], a[72:75], a[136:139], v[96:111]
    v_max3_f32 v25, v70, v71, v25
    v_mfma_f32_32x32x16_bf16 v[112:127], a[104:107], a[136:139], v[112:127]
    v_max3_f32 v25, v72, v73, v25
    v_mfma_f32_32x32x16_bf16 v[96:111], a[76:79], a[140:143], v[96:111]
    v_max3_f32 v25, v74, v75, v25
    v_mfma_f32_32x32x16_bf16 v[112:127], a[108:111], a[140:143], v[112:127]
    v_max3_f32 v25, v76, v77, v25
    v_mfma_f32_32x32x16_bf16 v[96:111], a[80:83], a[144:147], v[96:111]
    v_max3_f32 v25, v78, v79, v25
    v_mfma_f32_32x32x16_bf16 v[112:127], a[112:115], a[144:147], v[112:127]
    v_max3_f32 v25, v80, v81, v25
    v_max3_f32 v25, v82, v83, v25
    v_mfma_f32_32x32x16_bf16 v[96:111], a[84:87], a[148:151], v[96:111]
    v_max3_f32 v25, v84, v85, v25
    v_mfma_f32_32x32x16_bf16 v[112:127], a[116:119], a[148:151], v[112:127]
    v_max3_f32 v25, v86, v87, v25
    v_mfma_f32_32x32x16_bf16 v[96:111], a[88:91], a[152:155], v[96:111]
    v_max3_f32 v25, v88, v89, v25
    v_mfma_f32_32x32x16_bf16 v[112:127], a[120:123], a[152:155], v[112:127]
    v_max3_f32 v25, v90, v91, v25
    v_mfma_f32_32x32x16_bf16 v[96:111], a[92:95], a[156:159], v[96:111]
    v_max3_f32 v25, v92, v93, v25
    v_mfma_f32_32x32x16_bf16 v[112:127], a[124:127], a[156:159], v[112:127]
    v_max3_f32 v25, v94, v95, v25
    v_mfma_f32_32x32x16_bf16 v[128:143], a[0:3], a[160:163], 0
    v_mfma_f32_32x32x16_bf16 v[144:159], a[32:35], a[160:163], 0
    s_waitcnt lgkmcnt(14)
    v_mfma_f32_32x32x16_bf16 v[128:143], a[4:7], a[164:167], v[128:143]
    s_nop 4
    v_max3_f32 v25, v96, v97, v25
    v_max3_f32 v25, v98, v99, v25
    v_max3_f32 v25, v100, v101, v25
    v_max3_f32 v25, v102, v103, v25
    v_mfma_f32_32x32x16_bf16 v[144:159], a[36:39], a[164:167], v[144:159]
    v_max3_f32 v25, v104, v105, v25
    v_max3_f32 v25, v106, v107, v25
    v_max3_f32 v25, v108, v109, v25
    v_max3_f32 v25, v110, v111, v25
    v_max3_f32 v25, v112, v113, v25
    v_max3_f32 v25, v114, v115, v25
    v_max3_f32 v25, v116, v117, v25
    s_waitcnt lgkmcnt(13)
    v_mfma_f32_32x32x16_bf16 v[128:143], a[8:11], a[168:171], v[128:143]
    v_max3_f32 v25, v118, v119, v25
    v_max3_f32 v25, v120, v121, v25
    v_max3_f32 v25, v122, v123, v25
    v_max3_f32 v25, v124, v125, v25
    v_max3_f32 v25, v126, v127, v25
    v_mov_b32 v20, v25
    s_nop 1
    v_permlane32_swap_b32 v20, v25
    v_max_f32 v25, v20, v25
    ds_write_b32 v23, v25 offset:0
    s_waitcnt lgkmcnt(0)
    s_barrier
    ds_read_b128 v[44:47], v24 offset:0
    v_mfma_f32_32x32x16_bf16 v[144:159], a[40:43], a[168:171], v[144:159]
    v_mfma_f32_32x32x16_bf16 v[128:143], a[12:15], a[172:175], v[128:143]
    v_mfma_f32_32x32x16_bf16 v[144:159], a[44:47], a[172:175], v[144:159]
    s_waitcnt lgkmcnt(0)
    v_max3_f32 v44, v44, v45, v46
    v_max_f32 v44, v44, v47
    v_mul_f32 v30, s66, v44
    v_mul_f32 v31, s66, v44
    v_fma_f32 v64, v64, s64, v30
    v_mfma_f32_32x32x16_bf16 v[128:143], a[16:19], a[176:179], v[128:143]
    v_fma_f32 v65, v65, s64, v30
    v_fma_f32 v66, v66, s64, v30
    v_fma_f32 v67, v67, s64, v30
    v_mfma_f32_32x32x16_bf16 v[144:159], a[48:51], a[176:179], v[144:159]
    v_exp_f32 v64, v64
    v_fma_f32 v68, v68, s64, v30
    v_exp_f32 v65, v65
    s_mov_b32 s49, 98304
    s_add_u32 m0, s47, 49152
    s_nop 0
    buffer_load_dwordx4 v3, s[32:35], s49 offen offset:0 nt lds
    v_fma_f32 v69, v69, s64, v30
    v_exp_f32 v66, v66
    v_fma_f32 v70, v70, s64, v30
    v_mfma_f32_32x32x16_bf16 v[128:143], a[20:23], a[180:183], v[128:143]
    v_exp_f32 v67, v67
    v_fma_f32 v71, v71, s64, v30
    v_exp_f32 v68, v68
    v_mfma_f32_32x32x16_bf16 v[144:159], a[52:55], a[180:183], v[144:159]
    v_fma_f32 v72, v72, s64, v30
    v_exp_f32 v69, v69
    v_fma_f32 v73, v73, s64, v30
    v_exp_f32 v70, v70
    buffer_load_dwordx4 v3, s[32:35], s49 offen offset:1024 nt lds
    v_fma_f32 v74, v74, s64, v30
    v_exp_f32 v71, v71
    v_fma_f32 v75, v75, s64, v30
    v_mfma_f32_32x32x16_bf16 v[128:143], a[24:27], a[184:187], v[128:143]
    v_add_f32 v36, v64, v66
    v_add_f32 v37, v65, v67
    v_cvt_pk_bf16_f32 v64, v64, v65
    v_mfma_f32_32x32x16_bf16 v[144:159], a[56:59], a[184:187], v[144:159]
    v_cvt_pk_bf16_f32 v65, v66, v67
    v_exp_f32 v72, v72
    v_fma_f32 v76, v76, s64, v30
    buffer_load_dwordx4 v3, s[32:35], s49 offen offset:2048 nt lds
    v_exp_f32 v73, v73
    v_fma_f32 v77, v77, s64, v30
    v_add_f32 v36, v36, v68
    v_mfma_f32_32x32x16_bf16 v[128:143], a[28:31], a[188:191], v[128:143]
    v_add_f32 v37, v37, v69
    v_cvt_pk_bf16_f32 v66, v68, v69
    v_exp_f32 v74, v74
    v_fma_f32 v78, v78, s64, v30
    v_mfma_f32_32x32x16_bf16 v[144:159], a[60:63], a[188:191], v[144:159]
    v_exp_f32 v75, v75
    v_fma_f32 v79, v79, s64, v30
    v_add_f32 v36, v36, v70
    buffer_load_dwordx4 v3, s[32:35], s49 offen offset:3072 nt lds
    v_add_f32 v37, v37, v71
    v_cvt_pk_bf16_f32 v67, v70, v71
    v_exp_f32 v76, v76
    v_mfma_f32_32x32x16_bf16 v[160:175], a[64:67], a[160:163], 0
    v_exp_f32 v77, v77
    v_add_f32 v36, v36, v72
    v_add_f32 v37, v37, v73
    v_mfma_f32_32x32x16_bf16 v[176:191], a[96:99], a[160:163], 0
    v_cvt_pk_bf16_f32 v68, v72, v73
    v_exp_f32 v78, v78
    v_exp_f32 v79, v79
    v_add_f32 v36, v36, v74
    v_add_f32 v37, v37, v75
    v_cvt_pk_bf16_f32 v69, v74, v75
    v_add_f32 v36, v36, v76
    v_mfma_f32_32x32x16_bf16 v[160:175], a[68:71], a[164:167], v[160:175]
    v_add_f32 v37, v37, v77
    v_cvt_pk_bf16_f32 v70, v76, v77
    v_add_f32 v36, v36, v78
    v_mfma_f32_32x32x16_bf16 v[176:191], a[100:103], a[164:167], v[176:191]
    v_add_f32 v37, v37, v79
    v_cvt_pk_bf16_f32 v71, v78, v79
    v_fma_f32 v80, v80, s64, v30
    s_mov_b32 s49, 114688
    s_add_u32 m0, s47, 98304
    s_nop 0
    buffer_load_dwordx4 v3, s[32:35], s49 offen offset:0 nt lds
    v_fma_f32 v81, v81, s64, v30
    v_fma_f32 v82, v82, s64, v30
    v_fma_f32 v83, v83, s64, v30
    v_mfma_f32_32x32x16_bf16 v[160:175], a[72:75], a[168:171], v[160:175]
    v_exp_f32 v80, v80
    v_fma_f32 v84, v84, s64, v30
    v_exp_f32 v81, v81
    v_mfma_f32_32x32x16_bf16 v[176:191], a[104:107], a[168:171], v[176:191]
    v_fma_f32 v85, v85, s64, v30
    v_exp_f32 v82, v82
    v_fma_f32 v86, v86, s64, v30
    v_exp_f32 v83, v83
    buffer_load_dwordx4 v3, s[32:35], s49 offen offset:1024 nt lds
    v_fma_f32 v87, v87, s64, v30
    v_exp_f32 v84, v84
    v_fma_f32 v88, v88, s64, v30
    v_mfma_f32_32x32x16_bf16 v[160:175], a[76:79], a[172:175], v[160:175]
    v_exp_f32 v85, v85
    v_fma_f32 v89, v89, s64, v30
    v_add_f32 v36, v36, v80
    v_mfma_f32_32x32x16_bf16 v[176:191], a[108:111], a[172:175], v[176:191]
    v_add_f32 v37, v37, v81
    v_cvt_pk_bf16_f32 v80, v80, v81
    v_exp_f32 v86, v86
    buffer_load_dwordx4 v3, s[32:35], s49 offen offset:2048 nt lds
    v_fma_f32 v90, v90, s64, v30
    v_exp_f32 v87, v87
    v_fma_f32 v91, v91, s64, v30
    v_mfma_f32_32x32x16_bf16 v[160:175], a[80:83], a[176:179], v[160:175]
    v_add_f32 v36, v36, v82
    v_add_f32 v37, v37, v83
    v_cvt_pk_bf16_f32 v81, v82, v83
    v_exp_f32 v88, v88
    v_mfma_f32_32x32x16_bf16 v[176:191], a[112:115], a[176:179], v[176:191]
    v_fma_f32 v92, v92, s64, v30
    v_exp_f32 v89, v89
    v_fma_f32 v93, v93, s64, v30
    buffer_load_dwordx4 v3, s[32:35], s49 offen offset:3072 nt lds
    v_add_f32 v36, v36, v84
    v_add_f32 v37, v37, v85
    v_cvt_pk_bf16_f32 v82, v84, v85
    v_mfma_f32_32x32x16_bf16 v[160:175], a[84:87], a[180:183], v[160:175]
    v_exp_f32 v90, v90
    v_fma_f32 v94, v94, s64, v30
    v_exp_f32 v91, v91
    v_mfma_f32_32x32x16_bf16 v[176:191], a[116:119], a[180:183], v[176:191]
    v_fma_f32 v95, v95, s64, v30
    v_add_f32 v36, v36, v86
    v_add_f32 v37, v37, v87
    v_cvt_pk_bf16_f32 v83, v86, v87
    v_exp_f32 v92, v92
    v_exp_f32 v93, v93
    v_add_f32 v36, v36, v88
    v_mfma_f32_32x32x16_bf16 v[160:175], a[88:91], a[184:187], v[160:175]
    v_add_f32 v37, v37, v89
    v_cvt_pk_bf16_f32 v84, v88, v89
    v_exp_f32 v94, v94
    v_mfma_f32_32x32x16_bf16 v[176:191], a[120:123], a[184:187], v[176:191]
    v_exp_f32 v95, v95
    v_add_f32 v36, v36, v90
    v_add_f32 v37, v37, v91
    buffer_load_dword v61, v58, s[68:71], s86 offen
    v_add_u32 v58, 131072, v58
    buffer_load_dword v62, v58, s[68:71], s86 offen
    buffer_load_dword v19, off, s[76:79], s83 sc1
    v_cvt_pk_bf16_f32 v85, v90, v91
    v_add_f32 v36, v36, v92
    v_add_f32 v37, v37, v93
    v_mfma_f32_32x32x16_bf16 v[160:175], a[92:95], a[188:191], v[160:175]
    v_cvt_pk_bf16_f32 v86, v92, v93
    v_add_f32 v36, v36, v94
    v_add_f32 v37, v37, v95
    v_mfma_f32_32x32x16_bf16 v[176:191], a[124:127], a[188:191], v[176:191]
    v_cvt_pk_bf16_f32 v87, v94, v95
    v_fma_f32 v96, v96, s64, v30
    v_fma_f32 v97, v97, s64, v30
    v_fma_f32 v98, v98, s64, v30
    v_mfma_f32_32x32x16_bf16 v[192:207], a[0:3], a[192:195], 0
    v_fma_f32 v99, v99, s64, v30
    v_exp_f32 v96, v96
    v_fma_f32 v100, v100, s64, v30
    v_exp_f32 v97, v97
    v_fma_f32 v101, v101, s64, v30
    v_mfma_f32_32x32x16_bf16 v[208:223], a[32:35], a[192:195], 0
    v_exp_f32 v98, v98
    v_fma_f32 v102, v102, s64, v30
    v_max_f32 v26, v128, v129
    v_max3_f32 v26, v130, v131, v26
    v_max3_f32 v26, v132, v133, v26
    v_mfma_f32_32x32x16_bf16 v[192:207], a[4:7], a[196:199], v[192:207]
    v_max3_f32 v26, v134, v135, v26
    v_max3_f32 v26, v136, v137, v26
    v_max3_f32 v26, v138, v139, v26
    v_max3_f32 v26, v140, v141, v26
    v_max3_f32 v26, v142, v143, v26
    v_mfma_f32_32x32x16_bf16 v[208:223], a[36:39], a[196:199], v[208:223]
    v_max3_f32 v26, v144, v145, v26
    v_max3_f32 v26, v146, v147, v26
    v_max3_f32 v26, v148, v149, v26
    v_max3_f32 v26, v150, v151, v26
    v_max3_f32 v26, v152, v153, v26
    v_mfma_f32_32x32x16_bf16 v[192:207], a[8:11], a[200:203], v[192:207]
    v_max3_f32 v26, v154, v155, v26
    v_max3_f32 v26, v156, v157, v26
    v_max3_f32 v26, v158, v159, v26
    v_max3_f32 v26, v160, v161, v26
    v_max3_f32 v26, v162, v163, v26
    v_mfma_f32_32x32x16_bf16 v[208:223], a[40:43], a[200:203], v[208:223]
    v_max3_f32 v26, v164, v165, v26
    v_max3_f32 v26, v166, v167, v26
    v_max3_f32 v26, v168, v169, v26
    v_max3_f32 v26, v170, v171, v26
    v_max3_f32 v26, v172, v173, v26
    v_mfma_f32_32x32x16_bf16 v[192:207], a[12:15], a[204:207], v[192:207]
    v_max3_f32 v26, v174, v175, v26
    v_max3_f32 v26, v176, v177, v26
    v_max3_f32 v26, v178, v179, v26
    v_max3_f32 v26, v180, v181, v26
    v_max3_f32 v26, v182, v183, v26
    v_mfma_f32_32x32x16_bf16 v[208:223], a[44:47], a[204:207], v[208:223]
    v_max3_f32 v26, v184, v185, v26
    v_max3_f32 v26, v186, v187, v26
    v_max3_f32 v26, v188, v189, v26
    v_max3_f32 v26, v190, v191, v26
    v_mov_b32 v20, v26
    s_nop 1
    v_permlane32_swap_b32 v20, v26
    v_max_f32 v26, v20, v26
    ds_write_b32 v23, v26 offset:512
    v_exp_f32 v99, v99
    v_mfma_f32_32x32x16_bf16 v[192:207], a[16:19], a[208:211], v[192:207]
    v_fma_f32 v103, v103, s64, v30
    v_exp_f32 v100, v100
    v_fma_f32 v104, v104, s64, v30
    v_exp_f32 v101, v101
    v_fma_f32 v105, v105, s64, v30
    v_mfma_f32_32x32x16_bf16 v[208:223], a[48:51], a[208:211], v[208:223]
    v_add_f32 v36, v36, v96
    v_add_f32 v37, v37, v97
    v_cvt_pk_bf16_f32 v96, v96, v97
    v_exp_f32 v102, v102
    s_waitcnt lgkmcnt(0)
    s_barrier
    ds_read_b128 v[48:51], v24 offset:512
    v_fma_f32 v106, v106, s64, v30
    v_mfma_f32_32x32x16_bf16 v[192:207], a[20:23], a[212:215], v[192:207]
    v_exp_f32 v103, v103
    v_fma_f32 v107, v107, s64, v30
    v_add_f32 v36, v36, v98
    v_add_f32 v37, v37, v99
    v_cvt_pk_bf16_f32 v97, v98, v99
    v_mfma_f32_32x32x16_bf16 v[208:223], a[52:55], a[212:215], v[208:223]
    v_exp_f32 v104, v104
    v_fma_f32 v108, v108, s64, v30
    v_exp_f32 v105, v105
    v_fma_f32 v109, v109, s64, v30
    v_add_f32 v36, v36, v100
    v_add_f32 v37, v37, v101
    v_mfma_f32_32x32x16_bf16 v[192:207], a[24:27], a[216:219], v[192:207]
    v_cvt_pk_bf16_f32 v98, v100, v101
    v_exp_f32 v106, v106
    v_fma_f32 v110, v110, s64, v30
    v_exp_f32 v107, v107
    v_fma_f32 v111, v111, s64, v30
    v_add_f32 v36, v36, v102
    v_mfma_f32_32x32x16_bf16 v[208:223], a[56:59], a[216:219], v[208:223]
    v_add_f32 v37, v37, v103
    v_cvt_pk_bf16_f32 v99, v102, v103
    v_exp_f32 v108, v108
    v_exp_f32 v109, v109
    v_add_f32 v36, v36, v104
    v_add_f32 v37, v37, v105
    v_mfma_f32_32x32x16_bf16 v[192:207], a[28:31], a[220:223], v[192:207]
    v_cvt_pk_bf16_f32 v100, v104, v105
    v_exp_f32 v110, v110
    v_exp_f32 v111, v111
    v_add_f32 v36, v36, v106
    v_add_f32 v37, v37, v107
    v_mfma_f32_32x32x16_bf16 v[208:223], a[60:63], a[220:223], v[208:223]
    v_cvt_pk_bf16_f32 v101, v106, v107
    v_add_f32 v36, v36, v108
    v_add_f32 v37, v37, v109
    v_cvt_pk_bf16_f32 v102, v108, v109
    v_add_f32 v36, v36, v110
    v_add_f32 v37, v37, v111
    v_mfma_f32_32x32x16_bf16 v[224:239], a[64:67], a[192:195], 0
    v_cvt_pk_bf16_f32 v103, v110, v111
    v_fma_f32 v112, v112, s64, v30
    v_fma_f32 v113, v113, s64, v30
    v_fma_f32 v114, v114, s64, v30
    v_fma_f32 v115, v115, s64, v30
    v_exp_f32 v112, v112
    v_mfma_f32_32x32x16_bf16 v[240:255], a[96:99], a[192:195], 0
    v_fma_f32 v116, v116, s64, v30
    v_exp_f32 v113, v113
    v_fma_f32 v117, v117, s64, v30
    v_exp_f32 v114, v114
    v_fma_f32 v118, v118, s64, v30
    v_exp_f32 v115, v115
    v_mfma_f32_32x32x16_bf16 v[224:239], a[68:71], a[196:199], v[224:239]
    v_fma_f32 v119, v119, s64, v30
    v_exp_f32 v116, v116
    v_fma_f32 v120, v120, s64, v30
    v_exp_f32 v117, v117
    v_fma_f32 v121, v121, s64, v30
    v_mfma_f32_32x32x16_bf16 v[240:255], a[100:103], a[196:199], v[240:255]
    v_add_f32 v36, v36, v112
    v_add_f32 v37, v37, v113
    v_cvt_pk_bf16_f32 v112, v112, v113
    v_exp_f32 v118, v118
    v_fma_f32 v122, v122, s64, v30
    v_exp_f32 v119, v119
    v_mfma_f32_32x32x16_bf16 v[224:239], a[72:75], a[200:203], v[224:239]
    v_fma_f32 v123, v123, s64, v30
    v_add_f32 v36, v36, v114
    v_add_f32 v37, v37, v115
    v_cvt_pk_bf16_f32 v113, v114, v115
    v_exp_f32 v120, v120
    v_fma_f32 v124, v124, s64, v30
    v_mfma_f32_32x32x16_bf16 v[240:255], a[104:107], a[200:203], v[240:255]
    v_exp_f32 v121, v121
    v_fma_f32 v125, v125, s64, v30
    v_add_f32 v36, v36, v116
    v_add_f32 v37, v37, v117
    v_cvt_pk_bf16_f32 v114, v116, v117
    v_exp_f32 v122, v122
    v_mfma_f32_32x32x16_bf16 v[224:239], a[76:79], a[204:207], v[224:239]
    v_fma_f32 v126, v126, s64, v30
    v_exp_f32 v123, v123
    v_fma_f32 v127, v127, s64, v30
    v_add_f32 v36, v36, v118
    v_add_f32 v37, v37, v119
    v_mfma_f32_32x32x16_bf16 v[240:255], a[108:111], a[204:207], v[240:255]
    v_cvt_pk_bf16_f32 v115, v118, v119
    v_exp_f32 v124, v124
    v_exp_f32 v125, v125
    v_add_f32 v36, v36, v120
    v_add_f32 v37, v37, v121
    v_cvt_pk_bf16_f32 v116, v120, v121
    v_mfma_f32_32x32x16_bf16 v[224:239], a[80:83], a[208:211], v[224:239]
    v_exp_f32 v126, v126
    v_exp_f32 v127, v127
    v_add_f32 v36, v36, v122
    v_add_f32 v37, v37, v123
    v_cvt_pk_bf16_f32 v117, v122, v123
    v_add_f32 v36, v36, v124
    v_mfma_f32_32x32x16_bf16 v[240:255], a[112:115], a[208:211], v[240:255]
    v_add_f32 v37, v37, v125
    v_cvt_pk_bf16_f32 v118, v124, v125
    v_add_f32 v36, v36, v126
    v_add_f32 v37, v37, v127
    v_cvt_pk_bf16_f32 v119, v126, v127
    v_add_f32 v36, v36, v37
    v_mov_b32 v37, v36
    s_nop 1
    v_permlane32_swap_b32 v37, v36
    v_add_f32 v36, v36, v37
    ds_write_b32 v23, v36 offset:1536
    s_waitcnt lgkmcnt(1)
    v_max3_f32 v48, v48, v49, v50
    v_max_f32 v48, v48, v51
    v_mul_f32 v32, s66, v48
    v_mul_f32 v33, s66, v48
    v_fma_f32 v128, v128, s64, v32
    v_mfma_f32_32x32x16_bf16 v[224:239], a[84:87], a[212:215], v[224:239]
    v_fma_f32 v129, v129, s64, v32
    v_fma_f32 v130, v130, s64, v32
    v_fma_f32 v131, v131, s64, v32
    v_mfma_f32_32x32x16_bf16 v[240:255], a[116:119], a[212:215], v[240:255]
    v_exp_f32 v128, v128
    v_fma_f32 v132, v132, s64, v32
    v_exp_f32 v129, v129
    v_mfma_f32_32x32x16_bf16 v[224:239], a[88:91], a[216:219], v[224:239]
    v_fma_f32 v133, v133, s64, v32
    v_exp_f32 v130, v130
    v_fma_f32 v134, v134, s64, v32
    v_exp_f32 v131, v131
    v_mfma_f32_32x32x16_bf16 v[240:255], a[120:123], a[216:219], v[240:255]
    v_fma_f32 v135, v135, s64, v32
    v_exp_f32 v132, v132
    v_fma_f32 v136, v136, s64, v32
    v_mfma_f32_32x32x16_bf16 v[224:239], a[92:95], a[220:223], v[224:239]
    v_exp_f32 v133, v133
    v_fma_f32 v137, v137, s64, v32
    v_exp_f32 v134, v134
    v_mfma_f32_32x32x16_bf16 v[240:255], a[124:127], a[220:223], v[240:255]
    v_fma_f32 v138, v138, s64, v32
    v_exp_f32 v135, v135
    v_fma_f32 v139, v139, s64, v32
    v_add_f32 v38, v128, v130
    ds_write_b128 v22, v[64:67] offset:0
    v_add_f32 v39, v129, v131
    v_cvt_pk_bf16_f32 v128, v128, v129
    v_cvt_pk_bf16_f32 v129, v130, v131
    ds_write_b128 v22, v[68:71] offset:1024
    v_exp_f32 v136, v136
    v_fma_f32 v140, v140, s64, v32
    v_exp_f32 v137, v137
    ds_write_b128 v22, v[80:83] offset:2048
    v_fma_f32 v141, v141, s64, v32
    v_add_f32 v38, v38, v132
    v_add_f32 v39, v39, v133
    v_cvt_pk_bf16_f32 v130, v132, v133
    ds_write_b128 v22, v[84:87] offset:3072
    v_exp_f32 v138, v138
    v_fma_f32 v142, v142, s64, v32
    v_exp_f32 v139, v139
    ds_write_b128 v22, v[96:99] offset:4096
    v_fma_f32 v143, v143, s64, v32
    v_add_f32 v38, v38, v134
    v_add_f32 v39, v39, v135
    ds_write_b128 v22, v[100:103] offset:5120
    v_cvt_pk_bf16_f32 v131, v134, v135
    v_exp_f32 v140, v140
    v_exp_f32 v141, v141
    v_add_f32 v38, v38, v136
    v_add_f32 v39, v39, v137
    v_cvt_pk_bf16_f32 v132, v136, v137
    v_exp_f32 v142, v142
    v_exp_f32 v143, v143
    v_add_f32 v38, v38, v138
    v_add_f32 v39, v39, v139
    v_cvt_pk_bf16_f32 v133, v138, v139
    v_max_f32 v27, v192, v193
    v_max3_f32 v27, v194, v195, v27
    v_max3_f32 v27, v196, v197, v27
    v_max3_f32 v27, v198, v199, v27
    v_max3_f32 v27, v200, v201, v27
    v_max3_f32 v27, v202, v203, v27
    v_max3_f32 v27, v204, v205, v27
    v_max3_f32 v27, v206, v207, v27
    v_max3_f32 v27, v208, v209, v27
    v_max3_f32 v27, v210, v211, v27
    v_max3_f32 v27, v212, v213, v27
    v_max3_f32 v27, v214, v215, v27
    v_max3_f32 v27, v216, v217, v27
    v_max3_f32 v27, v218, v219, v27
    v_max3_f32 v27, v220, v221, v27
    v_max3_f32 v27, v222, v223, v27
    v_max3_f32 v27, v224, v225, v27
    v_max3_f32 v27, v226, v227, v27
    v_max3_f32 v27, v228, v229, v27
    v_max3_f32 v27, v230, v231, v27
    v_max3_f32 v27, v232, v233, v27
    v_max3_f32 v27, v234, v235, v27
    v_max3_f32 v27, v236, v237, v27
    v_max3_f32 v27, v238, v239, v27
    v_max3_f32 v27, v240, v241, v27
    v_max3_f32 v27, v242, v243, v27
    v_max3_f32 v27, v244, v245, v27
    v_max3_f32 v27, v246, v247, v27
    v_max3_f32 v27, v248, v249, v27
    v_max3_f32 v27, v250, v251, v27
    v_max3_f32 v27, v252, v253, v27
    v_max3_f32 v27, v254, v255, v27
    v_mov_b32 v20, v27
    s_nop 1
    v_permlane32_swap_b32 v20, v27
    v_max_f32 v27, v20, v27
    ds_write_b32 v23, v27 offset:1024
    s_waitcnt vmcnt(31) lgkmcnt(0)
    s_barrier
    ds_read_b128 v[52:55], v24 offset:1024
    v_add_f32 v38, v38, v140
    ds_read_b64_tr_b16 a[0:1], v42 offset:49152
    v_add_f32 v39, v39, v141
    v_cvt_pk_bf16_f32 v134, v140, v141
    v_add_f32 v38, v38, v142
    ds_read_b64_tr_b16 a[2:3], v42 offset:51200
    v_add_f32 v39, v39, v143
    v_cvt_pk_bf16_f32 v135, v142, v143
    v_fma_f32 v144, v144, s64, v32
    ds_read_b64_tr_b16 a[4:5], v42 offset:53248
    v_fma_f32 v145, v145, s64, v32
    v_fma_f32 v146, v146, s64, v32
    v_fma_f32 v147, v147, s64, v32
    ds_read_b64_tr_b16 a[6:7], v42 offset:55296
    v_exp_f32 v144, v144
    v_fma_f32 v148, v148, s64, v32
    v_exp_f32 v145, v145
    ds_read_b64_tr_b16 a[8:9], v42 offset:57344
    v_fma_f32 v149, v149, s64, v32
    v_exp_f32 v146, v146
    v_fma_f32 v150, v150, s64, v32
    ds_read_b64_tr_b16 a[10:11], v42 offset:59392
    v_exp_f32 v147, v147
    v_fma_f32 v151, v151, s64, v32
    v_exp_f32 v148, v148
    ds_read_b64_tr_b16 a[12:13], v42 offset:61440
    v_fma_f32 v152, v152, s64, v32
    v_exp_f32 v149, v149
    v_fma_f32 v153, v153, s64, v32
    ds_read_b64_tr_b16 a[14:15], v42 offset:63488
    v_add_f32 v38, v38, v144
    v_add_f32 v39, v39, v145
    v_cvt_pk_bf16_f32 v144, v144, v145
    ds_read_b128 v[80:83], v21 offset:0
    v_exp_f32 v150, v150
    v_fma_f32 v154, v154, s64, v32
    v_exp_f32 v151, v151
    ds_read_b128 v[84:87], v21 offset:8192
    v_fma_f32 v155, v155, s64, v32
    v_add_f32 v38, v38, v146
    v_add_f32 v39, v39, v147
    ds_read_b128 v[88:91], v21 offset:16384
    v_cvt_pk_bf16_f32 v145, v146, v147
    v_exp_f32 v152, v152
    v_fma_f32 v156, v156, s64, v32
    ds_read_b128 v[92:95], v21 offset:24576
    v_exp_f32 v153, v153
    v_fma_f32 v157, v157, s64, v32
    s_waitcnt vmcnt(27) lgkmcnt(0)
    s_barrier
    v_add_f32 v38, v38, v148
    ds_read_b64_tr_b16 a[16:17], v43 offset:0
    v_add_f32 v39, v39, v149
    v_cvt_pk_bf16_f32 v146, v148, v149
    ds_read_b64_tr_b16 a[18:19], v43 offset:2048
    v_exp_f32 v154, v154
    v_fma_f32 v158, v158, s64, v32
    v_exp_f32 v155, v155
    ds_read_b64_tr_b16 a[20:21], v43 offset:4096
    v_fma_f32 v159, v159, s64, v32
    v_add_f32 v38, v38, v150
    v_add_f32 v39, v39, v151
    ds_read_b64_tr_b16 a[22:23], v43 offset:6144
    v_cvt_pk_bf16_f32 v147, v150, v151
    v_exp_f32 v156, v156
    v_exp_f32 v157, v157
    ds_read_b64_tr_b16 a[24:25], v43 offset:8192
    v_add_f32 v38, v38, v152
    v_add_f32 v39, v39, v153
    v_cvt_pk_bf16_f32 v148, v152, v153
    ds_read_b64_tr_b16 a[26:27], v43 offset:10240
    v_exp_f32 v158, v158
    v_exp_f32 v159, v159
    v_add_f32 v38, v38, v154
    ds_read_b64_tr_b16 a[28:29], v43 offset:12288
    v_add_f32 v39, v39, v155
    v_cvt_pk_bf16_f32 v149, v154, v155
    v_add_f32 v38, v38, v156
    ds_read_b64_tr_b16 a[30:31], v43 offset:14336
    v_add_f32 v39, v39, v157
    v_cvt_pk_bf16_f32 v150, v156, v157
    v_add_f32 v38, v38, v158
    ds_read_b128 v[96:99], v21 offset:1024
    v_add_f32 v39, v39, v159
    v_cvt_pk_bf16_f32 v151, v158, v159
    ds_read_b128 v[100:103], v21 offset:9216
    v_fma_f32 v160, v160, s64, v32
    v_fma_f32 v161, v161, s64, v32
    v_fma_f32 v162, v162, s64, v32
    ds_read_b128 v[104:107], v21 offset:17408
    v_fma_f32 v163, v163, s64, v32
    v_exp_f32 v160, v160
    v_fma_f32 v164, v164, s64, v32
    ds_read_b128 v[108:111], v21 offset:25600
    v_exp_f32 v161, v161
    v_fma_f32 v165, v165, s64, v32
    v_exp_f32 v162, v162
    v_mfma_f32_32x32x16_bf16 v[64:79], a[0:3], v[80:83], 0
    v_fma_f32 v166, v166, s64, v32
    v_exp_f32 v163, v163
    v_fma_f32 v167, v167, s64, v32
    v_mfma_f32_32x32x16_bf16 v[64:79], a[4:7], v[84:87], v[64:79]
    v_exp_f32 v164, v164
    v_fma_f32 v168, v168, s64, v32
    v_exp_f32 v165, v165
    v_mfma_f32_32x32x16_bf16 v[64:79], a[8:11], v[88:91], v[64:79]
    v_fma_f32 v169, v169, s64, v32
    v_add_f32 v38, v38, v160
    v_add_f32 v39, v39, v161
    v_mfma_f32_32x32x16_bf16 v[64:79], a[12:15], v[92:95], v[64:79]
    v_cvt_pk_bf16_f32 v160, v160, v161
    v_exp_f32 v166, v166
    s_waitcnt vmcnt(23) lgkmcnt(0)
    s_barrier
    v_fma_f32 v170, v170, s64, v32
    ds_read_b64_tr_b16 a[32:33], v43 offset:16384
    v_exp_f32 v167, v167
    v_fma_f32 v171, v171, s64, v32
    v_add_f32 v38, v38, v162
    ds_read_b64_tr_b16 a[34:35], v43 offset:18432
    v_add_f32 v39, v39, v163
    v_cvt_pk_bf16_f32 v161, v162, v163
    v_exp_f32 v168, v168
    ds_read_b64_tr_b16 a[36:37], v43 offset:20480
    v_fma_f32 v172, v172, s64, v32
    v_exp_f32 v169, v169
    v_fma_f32 v173, v173, s64, v32
    ds_read_b64_tr_b16 a[38:39], v43 offset:22528
    v_add_f32 v38, v38, v164
    v_add_f32 v39, v39, v165
    v_cvt_pk_bf16_f32 v162, v164, v165
    ds_read_b64_tr_b16 a[40:41], v43 offset:24576
    v_exp_f32 v170, v170
    v_fma_f32 v174, v174, s64, v32
    v_exp_f32 v171, v171
    ds_read_b64_tr_b16 a[42:43], v43 offset:26624
    v_fma_f32 v175, v175, s64, v32
    v_add_f32 v38, v38, v166
    v_add_f32 v39, v39, v167
    ds_read_b64_tr_b16 a[44:45], v43 offset:28672
    v_cvt_pk_bf16_f32 v163, v166, v167
    v_exp_f32 v172, v172
    v_exp_f32 v173, v173
    ds_read_b64_tr_b16 a[46:47], v43 offset:30720
    v_add_f32 v38, v38, v168
    v_add_f32 v39, v39, v169
    v_cvt_pk_bf16_f32 v164, v168, v169
    v_exp_f32 v174, v174
    ds_read_b128 v[80:83], v21 offset:2048
    v_exp_f32 v175, v175
    v_add_f32 v38, v38, v170
    v_add_f32 v39, v39, v171
    ds_read_b128 v[84:87], v21 offset:10240
    v_cvt_pk_bf16_f32 v165, v170, v171
    v_add_f32 v38, v38, v172
    v_add_f32 v39, v39, v173
    ds_read_b128 v[88:91], v21 offset:18432
    v_cvt_pk_bf16_f32 v166, v172, v173
    v_add_f32 v38, v38, v174
    v_add_f32 v39, v39, v175
    ds_read_b128 v[92:95], v21 offset:26624
    v_cvt_pk_bf16_f32 v167, v174, v175
    v_fma_f32 v176, v176, s64, v32
    v_fma_f32 v177, v177, s64, v32
    v_mfma_f32_32x32x16_bf16 v[64:79], a[16:19], v[96:99], v[64:79]
    v_fma_f32 v178, v178, s64, v32
    v_fma_f32 v179, v179, s64, v32
    v_exp_f32 v176, v176
    v_mfma_f32_32x32x16_bf16 v[64:79], a[20:23], v[100:103], v[64:79]
    v_fma_f32 v180, v180, s64, v32
    v_exp_f32 v177, v177
    v_fma_f32 v181, v181, s64, v32
    v_mfma_f32_32x32x16_bf16 v[64:79], a[24:27], v[104:107], v[64:79]
    v_exp_f32 v178, v178
    v_fma_f32 v182, v182, s64, v32
    v_exp_f32 v179, v179
    v_mfma_f32_32x32x16_bf16 v[64:79], a[28:31], v[108:111], v[64:79]
    v_fma_f32 v183, v183, s64, v32
    v_exp_f32 v180, v180
    v_fma_f32 v184, v184, s64, v32
    v_exp_f32 v181, v181
    s_waitcnt lgkmcnt(3)
    v_mfma_f32_32x32x16_bf16 v[64:79], a[32:35], v[80:83], v[64:79]
    v_fma_f32 v185, v185, s64, v32
    v_add_f32 v38, v38, v176
    v_add_f32 v39, v39, v177
    v_cvt_pk_bf16_f32 v176, v176, v177
    v_exp_f32 v182, v182
    v_fma_f32 v186, v186, s64, v32
    v_exp_f32 v183, v183
    v_fma_f32 v187, v187, s64, v32
    v_add_f32 v38, v38, v178
    v_add_f32 v39, v39, v179
    s_waitcnt lgkmcnt(2)
    v_mfma_f32_32x32x16_bf16 v[64:79], a[36:39], v[84:87], v[64:79]
    v_cvt_pk_bf16_f32 v177, v178, v179
    v_exp_f32 v184, v184
    v_fma_f32 v188, v188, s64, v32
    v_exp_f32 v185, v185
    v_fma_f32 v189, v189, s64, v32
    v_add_f32 v38, v38, v180
    v_add_f32 v39, v39, v181
    v_cvt_pk_bf16_f32 v178, v180, v181
    v_exp_f32 v186, v186
    v_fma_f32 v190, v190, s64, v32
    v_exp_f32 v187, v187
    s_waitcnt lgkmcnt(1)
    v_mfma_f32_32x32x16_bf16 v[64:79], a[40:43], v[88:91], v[64:79]
    v_fma_f32 v191, v191, s64, v32
    v_add_f32 v38, v38, v182
    v_add_f32 v39, v39, v183
    v_cvt_pk_bf16_f32 v179, v182, v183
    v_exp_f32 v188, v188
    v_exp_f32 v189, v189
    v_add_f32 v38, v38, v184
    v_add_f32 v39, v39, v185
    v_cvt_pk_bf16_f32 v180, v184, v185
    v_exp_f32 v190, v190
    s_waitcnt lgkmcnt(0)
    v_mfma_f32_32x32x16_bf16 v[64:79], a[44:47], v[92:95], v[64:79]
    v_exp_f32 v191, v191
    v_add_f32 v38, v38, v186
    v_add_f32 v39, v39, v187
    v_cvt_pk_bf16_f32 v181, v186, v187
    v_add_f32 v38, v38, v188
    v_add_f32 v39, v39, v189
    v_cvt_pk_bf16_f32 v182, v188, v189
    v_add_f32 v38, v38, v190
    v_add_f32 v39, v39, v191
    v_cvt_pk_bf16_f32 v183, v190, v191
    v_add_f32 v38, v38, v39
    v_mov_b32 v39, v38
    s_nop 1
    v_permlane32_swap_b32 v39, v38
    v_add_f32 v38, v38, v39
    ds_write_b32 v23, v38 offset:0
    v_max3_f32 v52, v52, v53, v54
    v_max_f32 v52, v52, v55
    v_mul_f32 v34, s66, v52
    v_mul_f32 v35, s66, v52
    v_fma_f32 v192, v192, s64, v34
    ds_write_b128 v15, v[128:131] offset:0
    v_fma_f32 v193, v193, s64, v34
    ds_write_b128 v15, v[132:135] offset:1024
    v_fma_f32 v194, v194, s64, v34
    v_fma_f32 v195, v195, s64, v34
    ds_write_b128 v15, v[144:147] offset:2048
    v_exp_f32 v192, v192
    ds_write_b128 v15, v[148:151] offset:3072
    v_fma_f32 v196, v196, s64, v34
    v_exp_f32 v193, v193
    ds_write_b128 v15, v[160:163] offset:4096
    v_fma_f32 v197, v197, s64, v34
    ds_write_b128 v15, v[164:167] offset:5120
    v_exp_f32 v194, v194
    v_fma_f32 v198, v198, s64, v34
    ds_write_b128 v15, v[176:179] offset:6144
    v_exp_f32 v195, v195
    ds_write_b128 v15, v[180:183] offset:7168
    v_fma_f32 v199, v199, s64, v34
    s_waitcnt vmcnt(19) lgkmcnt(0)
    s_barrier
    v_exp_f32 v196, v196
    ds_read_b128 v[44:47], v24 offset:1536
    v_fma_f32 v200, v200, s64, v34
    ds_read_b128 v[48:51], v24 offset:0
    v_exp_f32 v197, v197
    ds_read_b128 v[144:147], v16 offset:0
    v_fma_f32 v201, v201, s64, v34
    v_exp_f32 v198, v198
    ds_read_b128 v[148:151], v16 offset:8192
    v_fma_f32 v202, v202, s64, v34
    ds_read_b128 v[152:155], v16 offset:16384
    v_exp_f32 v199, v199
    v_fma_f32 v203, v203, s64, v34
    ds_read_b128 v[156:159], v16 offset:24576
    v_add_f32 v40, v192, v194
    ds_read_b64_tr_b16 a[48:49], v42 offset:0
    v_add_f32 v41, v193, v195
    v_cvt_pk_bf16_f32 v192, v192, v193
    ds_read_b64_tr_b16 a[50:51], v42 offset:2048
    v_cvt_pk_bf16_f32 v193, v194, v195
    ds_read_b64_tr_b16 a[52:53], v42 offset:4096
    v_exp_f32 v200, v200
    ds_read_b64_tr_b16 a[54:55], v42 offset:6144
    v_fma_f32 v204, v204, s64, v34
    v_exp_f32 v201, v201
    ds_read_b64_tr_b16 a[56:57], v42 offset:8192
    v_fma_f32 v205, v205, s64, v34
    ds_read_b64_tr_b16 a[58:59], v42 offset:10240
    v_add_f32 v40, v40, v196
    v_add_f32 v41, v41, v197
    ds_read_b64_tr_b16 a[60:61], v42 offset:12288
    v_cvt_pk_bf16_f32 v194, v196, v197
    ds_read_b64_tr_b16 a[62:63], v42 offset:14336
    v_exp_f32 v202, v202
    v_fma_f32 v206, v206, s64, v34
    ds_read_b128 v[96:99], v21 offset:3072
    v_exp_f32 v203, v203
    ds_read_b128 v[100:103], v21 offset:11264
    v_fma_f32 v207, v207, s64, v34
    ds_read_b128 v[104:107], v21 offset:19456
    v_add_f32 v40, v40, v198
    v_add_f32 v41, v41, v199
    ds_read_b128 v[108:111], v21 offset:27648
    v_cvt_pk_bf16_f32 v195, v198, v199
    ds_read_b128 v[160:163], v16 offset:1024
    v_exp_f32 v204, v204
    v_exp_f32 v205, v205
    ds_read_b128 v[164:167], v16 offset:9216
    v_add_f32 v40, v40, v200
    ds_read_b128 v[168:171], v16 offset:17408
    v_add_f32 v41, v41, v201
    v_cvt_pk_bf16_f32 v196, v200, v201
    ds_read_b128 v[172:175], v16 offset:25600
    v_exp_f32 v206, v206
    s_add_u32 s49, s86, 0
    s_add_u32 m0, s47, 147456
    s_nop 0
    buffer_load_dwordx4 v4, s[68:71], s49 offen offset:0 lds
    v_exp_f32 v207, v207
    buffer_load_dwordx4 v5, s[68:71], s49 offen offset:1024 lds
    v_add_f32 v40, v40, v202
    v_add_f32 v41, v41, v203
    buffer_load_dwordx4 v6, s[68:71], s49 offen offset:2048 lds
    v_cvt_pk_bf16_f32 v197, v202, v203
    buffer_load_dwordx4 v7, s[68:71], s49 offen offset:3072 lds
    v_add_f32 v40, v40, v204
    v_add_f32 v41, v41, v205
    v_cvt_pk_bf16_f32 v198, v204, v205
    s_waitcnt lgkmcnt(15)
    v_mfma_f32_32x32x16_bf16 v[128:143], a[0:3], v[144:147], 0
    v_add_f32 v40, v40, v206
    v_add_f32 v41, v41, v207
    v_mfma_f32_32x32x16_bf16 v[128:143], a[4:7], v[148:151], v[128:143]
    v_cvt_pk_bf16_f32 v199, v206, v207
    v_mfma_f32_32x32x16_bf16 v[128:143], a[8:11], v[152:155], v[128:143]
    v_fma_f32 v208, v208, s64, v34
    v_mfma_f32_32x32x16_bf16 v[128:143], a[12:15], v[156:159], v[128:143]
    v_fma_f32 v209, v209, s64, v34
    v_fma_f32 v210, v210, s64, v34
    s_waitcnt lgkmcnt(7)
    v_mfma_f32_32x32x16_bf16 v[64:79], a[48:51], v[96:99], v[64:79]
    v_fma_f32 v211, v211, s64, v34
    s_waitcnt lgkmcnt(6)
    v_mfma_f32_32x32x16_bf16 v[64:79], a[52:55], v[100:103], v[64:79]
    v_exp_f32 v208, v208
    v_fma_f32 v212, v212, s64, v34
    s_waitcnt lgkmcnt(5)
    v_mfma_f32_32x32x16_bf16 v[64:79], a[56:59], v[104:107], v[64:79]
    v_exp_f32 v209, v209
    s_waitcnt lgkmcnt(4)
    v_mfma_f32_32x32x16_bf16 v[64:79], a[60:63], v[108:111], v[64:79]
    v_fma_f32 v213, v213, s64, v34
    s_waitcnt vmcnt(19) lgkmcnt(0)
    s_barrier
    v_exp_f32 v210, v210
    ds_write_b128 v22, v[112:115] offset:6144
    v_fma_f32 v214, v214, s64, v34
    ds_write_b128 v22, v[116:119] offset:7168
    v_exp_f32 v211, v211
    v_fma_f32 v215, v215, s64, v34
    ds_read_b64_tr_b16 a[64:65], v42 offset:16384
    v_exp_f32 v212, v212
    v_fma_f32 v216, v216, s64, v34
    ds_read_b64_tr_b16 a[66:67], v42 offset:18432
    v_exp_f32 v213, v213
    v_fma_f32 v217, v217, s64, v34
    ds_read_b64_tr_b16 a[68:69], v42 offset:20480
    v_add_f32 v40, v40, v208
    ds_read_b64_tr_b16 a[70:71], v42 offset:22528
    v_add_f32 v41, v41, v209
    v_cvt_pk_bf16_f32 v208, v208, v209
    ds_read_b64_tr_b16 a[72:73], v42 offset:24576
    v_exp_f32 v214, v214
    v_fma_f32 v218, v218, s64, v34
    ds_read_b64_tr_b16 a[74:75], v42 offset:26624
    v_exp_f32 v215, v215
    v_fma_f32 v219, v219, s64, v34
    ds_read_b64_tr_b16 a[76:77], v42 offset:28672
    v_add_f32 v40, v40, v210
    ds_read_b64_tr_b16 a[78:79], v42 offset:30720
    v_add_f32 v41, v41, v211
    v_cvt_pk_bf16_f32 v209, v210, v211
    ds_read_b128 v[80:83], v21 offset:4096
    v_exp_f32 v216, v216
    v_fma_f32 v220, v220, s64, v34
    ds_read_b128 v[84:87], v21 offset:12288
    v_exp_f32 v217, v217
    v_fma_f32 v221, v221, s64, v34
    ds_read_b128 v[88:91], v21 offset:20480
    v_add_f32 v40, v40, v212
    ds_read_b128 v[92:95], v21 offset:28672
    v_add_f32 v41, v41, v213
    v_cvt_pk_bf16_f32 v210, v212, v213
    v_mfma_f32_32x32x16_bf16 v[128:143], a[16:19], v[160:163], v[128:143]
    v_exp_f32 v218, v218
    v_fma_f32 v222, v222, s64, v34
    v_mfma_f32_32x32x16_bf16 v[128:143], a[20:23], v[164:167], v[128:143]
    v_exp_f32 v219, v219
    v_fma_f32 v223, v223, s64, v34
    v_mfma_f32_32x32x16_bf16 v[128:143], a[24:27], v[168:171], v[128:143]
    v_add_f32 v40, v40, v214
    v_add_f32 v41, v41, v215
    v_mfma_f32_32x32x16_bf16 v[128:143], a[28:31], v[172:175], v[128:143]
    v_cvt_pk_bf16_f32 v211, v214, v215
    ds_read_b128 v[144:147], v16 offset:2048
    v_exp_f32 v220, v220
    v_exp_f32 v221, v221
    ds_read_b128 v[148:151], v16 offset:10240
    v_add_f32 v40, v40, v216
    v_add_f32 v41, v41, v217
    ds_read_b128 v[152:155], v16 offset:18432
    v_cvt_pk_bf16_f32 v212, v216, v217
    v_exp_f32 v222, v222
    ds_read_b128 v[156:159], v16 offset:26624
    v_exp_f32 v223, v223
    s_waitcnt lgkmcnt(7)
    v_mfma_f32_32x32x16_bf16 v[64:79], a[64:67], v[80:83], v[64:79]
    v_add_f32 v40, v40, v218
    v_add_f32 v41, v41, v219
    s_waitcnt lgkmcnt(6)
    v_mfma_f32_32x32x16_bf16 v[64:79], a[68:71], v[84:87], v[64:79]
    v_cvt_pk_bf16_f32 v213, v218, v219
    v_add_f32 v40, v40, v220
    s_waitcnt lgkmcnt(5)
    v_mfma_f32_32x32x16_bf16 v[64:79], a[72:75], v[88:91], v[64:79]
    v_add_f32 v41, v41, v221
    v_cvt_pk_bf16_f32 v214, v220, v221
    s_waitcnt lgkmcnt(4)
    v_mfma_f32_32x32x16_bf16 v[64:79], a[76:79], v[92:95], v[64:79]
    v_add_f32 v40, v40, v222
    ds_read_b128 v[160:163], v16 offset:3072
    v_add_f32 v41, v41, v223
    v_cvt_pk_bf16_f32 v215, v222, v223
    ds_read_b128 v[164:167], v16 offset:11264
    v_fma_f32 v224, v224, s64, v34
    v_fma_f32 v225, v225, s64, v34
    ds_read_b128 v[168:171], v16 offset:19456
    v_fma_f32 v226, v226, s64, v34
    v_fma_f32 v227, v227, s64, v34
    ds_read_b128 v[172:175], v16 offset:27648
    v_exp_f32 v224, v224
    s_waitcnt lgkmcnt(7)
    v_mfma_f32_32x32x16_bf16 v[128:143], a[32:35], v[144:147], v[128:143]
    v_fma_f32 v228, v228, s64, v34
    v_exp_f32 v225, v225
    s_waitcnt lgkmcnt(6)
    v_mfma_f32_32x32x16_bf16 v[128:143], a[36:39], v[148:151], v[128:143]
    v_fma_f32 v229, v229, s64, v34
    v_exp_f32 v226, v226
    s_waitcnt lgkmcnt(5)
    v_mfma_f32_32x32x16_bf16 v[128:143], a[40:43], v[152:155], v[128:143]
    v_fma_f32 v230, v230, s64, v34
    v_exp_f32 v227, v227
    s_waitcnt lgkmcnt(4)
    v_mfma_f32_32x32x16_bf16 v[128:143], a[44:47], v[156:159], v[128:143]
    v_fma_f32 v231, v231, s64, v34
    s_waitcnt vmcnt(15) lgkmcnt(0)
    s_barrier
    v_exp_f32 v228, v228
    ds_read_b64_tr_b16 a[80:81], v8 offset:32768
    v_fma_f32 v232, v232, s64, v34
    v_exp_f32 v229, v229
    ds_read_b64_tr_b16 a[82:83], v8 offset:34816
    v_fma_f32 v233, v233, s64, v34
    v_add_f32 v40, v40, v224
    ds_read_b64_tr_b16 a[84:85], v8 offset:36864
    v_add_f32 v41, v41, v225
    v_cvt_pk_bf16_f32 v224, v224, v225
    ds_read_b64_tr_b16 a[86:87], v8 offset:38912
    v_exp_f32 v230, v230
    v_fma_f32 v234, v234, s64, v34
    ds_read_b64_tr_b16 a[88:89], v8 offset:40960
    v_exp_f32 v231, v231
    v_fma_f32 v235, v235, s64, v34
    ds_read_b64_tr_b16 a[90:91], v8 offset:43008
    v_add_f32 v40, v40, v226
    v_add_f32 v41, v41, v227
    ds_read_b64_tr_b16 a[92:93], v8 offset:45056
    v_cvt_pk_bf16_f32 v225, v226, v227
    v_exp_f32 v232, v232
    ds_read_b64_tr_b16 a[94:95], v8 offset:47104
    v_fma_f32 v236, v236, s64, v34
    v_exp_f32 v233, v233
    v_fma_f32 v237, v237, s64, v34
    ds_read_b128 v[96:99], v21 offset:5120
    v_add_f32 v40, v40, v228
    v_add_f32 v41, v41, v229
    ds_read_b128 v[100:103], v21 offset:13312
    v_cvt_pk_bf16_f32 v226, v228, v229
    v_exp_f32 v234, v234
    ds_read_b128 v[104:107], v21 offset:21504
    v_fma_f32 v238, v238, s64, v34
    v_exp_f32 v235, v235
    ds_read_b128 v[108:111], v21 offset:29696
    v_fma_f32 v239, v239, s64, v34
    v_add_f32 v40, v40, v230
    v_mfma_f32_32x32x16_bf16 v[128:143], a[48:51], v[160:163], v[128:143]
    v_add_f32 v41, v41, v231
    v_cvt_pk_bf16_f32 v227, v230, v231
    v_mfma_f32_32x32x16_bf16 v[128:143], a[52:55], v[164:167], v[128:143]
    v_exp_f32 v236, v236
    v_exp_f32 v237, v237
    v_mfma_f32_32x32x16_bf16 v[128:143], a[56:59], v[168:171], v[128:143]
    v_add_f32 v40, v40, v232
    v_add_f32 v41, v41, v233
    v_mfma_f32_32x32x16_bf16 v[128:143], a[60:63], v[172:175], v[128:143]
    v_cvt_pk_bf16_f32 v228, v232, v233
    v_exp_f32 v238, v238
    v_exp_f32 v239, v239
    ds_read_b128 v[144:147], v16 offset:4096
    v_add_f32 v40, v40, v234
    v_add_f32 v41, v41, v235
    ds_read_b128 v[148:151], v16 offset:12288
    v_cvt_pk_bf16_f32 v229, v234, v235
    v_add_f32 v40, v40, v236
    ds_read_b128 v[152:155], v16 offset:20480
    v_add_f32 v41, v41, v237
    v_cvt_pk_bf16_f32 v230, v236, v237
    ds_read_b128 v[156:159], v16 offset:28672
    v_add_f32 v40, v40, v238
    v_add_f32 v41, v41, v239
    s_waitcnt lgkmcnt(7)
    v_mfma_f32_32x32x16_bf16 v[64:79], a[80:83], v[96:99], v[64:79]
    v_cvt_pk_bf16_f32 v231, v238, v239
    v_fma_f32 v240, v240, s64, v34
    s_waitcnt lgkmcnt(6)
    v_mfma_f32_32x32x16_bf16 v[64:79], a[84:87], v[100:103], v[64:79]
    v_fma_f32 v241, v241, s64, v34
    v_fma_f32 v242, v242, s64, v34
    s_waitcnt lgkmcnt(5)
    v_mfma_f32_32x32x16_bf16 v[64:79], a[88:91], v[104:107], v[64:79]
    v_fma_f32 v243, v243, s64, v34
    v_exp_f32 v240, v240
    s_waitcnt lgkmcnt(4)
    v_mfma_f32_32x32x16_bf16 v[64:79], a[92:95], v[108:111], v[64:79]
    v_fma_f32 v244, v244, s64, v34
    v_exp_f32 v241, v241
    v_fma_f32 v245, v245, s64, v34
    ds_read_b128 v[160:163], v16 offset:5120
    v_exp_f32 v242, v242
    v_fma_f32 v246, v246, s64, v34
    ds_read_b128 v[164:167], v16 offset:13312
    v_exp_f32 v243, v243
    v_fma_f32 v247, v247, s64, v34
    ds_read_b128 v[168:171], v16 offset:21504
    v_exp_f32 v244, v244
    v_fma_f32 v248, v248, s64, v34
    ds_read_b128 v[172:175], v16 offset:29696
    v_exp_f32 v245, v245
    v_fma_f32 v249, v249, s64, v34
    s_waitcnt lgkmcnt(7)
    v_mfma_f32_32x32x16_bf16 v[128:143], a[64:67], v[144:147], v[128:143]
    v_add_f32 v40, v40, v240
    v_add_f32 v41, v41, v241
    s_waitcnt lgkmcnt(6)
    v_mfma_f32_32x32x16_bf16 v[128:143], a[68:71], v[148:151], v[128:143]
    v_cvt_pk_bf16_f32 v240, v240, v241
    v_exp_f32 v246, v246
    s_waitcnt lgkmcnt(5)
    v_mfma_f32_32x32x16_bf16 v[128:143], a[72:75], v[152:155], v[128:143]
    v_fma_f32 v250, v250, s64, v34
    v_exp_f32 v247, v247
    s_waitcnt lgkmcnt(4)
    v_mfma_f32_32x32x16_bf16 v[128:143], a[76:79], v[156:159], v[128:143]
    v_fma_f32 v251, v251, s64, v34
    v_add_f32 v40, v40, v242
    v_add_f32 v41, v41, v243
    s_waitcnt lgkmcnt(3)
    v_mfma_f32_32x32x16_bf16 v[128:143], a[80:83], v[160:163], v[128:143]
    v_cvt_pk_bf16_f32 v241, v242, v243
    v_exp_f32 v248, v248
    v_fma_f32 v252, v252, s64, v34
    v_exp_f32 v249, v249
    v_fma_f32 v253, v253, s64, v34
    v_add_f32 v40, v40, v244
    v_add_f32 v41, v41, v245
    v_cvt_pk_bf16_f32 v242, v244, v245
    v_exp_f32 v250, v250
    v_fma_f32 v254, v254, s64, v34
    s_waitcnt lgkmcnt(2)
    v_mfma_f32_32x32x16_bf16 v[128:143], a[84:87], v[164:167], v[128:143]
    v_exp_f32 v251, v251
    v_fma_f32 v255, v255, s64, v34
    v_add_f32 v40, v40, v246
    v_add_f32 v41, v41, v247
    v_cvt_pk_bf16_f32 v243, v246, v247
    v_exp_f32 v252, v252
    v_exp_f32 v253, v253
    v_add_f32 v40, v40, v248
    v_add_f32 v41, v41, v249
    v_cvt_pk_bf16_f32 v244, v248, v249
    v_exp_f32 v254, v254
    s_waitcnt lgkmcnt(1)
    v_mfma_f32_32x32x16_bf16 v[128:143], a[88:91], v[168:171], v[128:143]
    v_exp_f32 v255, v255
    v_add_f32 v40, v40, v250
    v_add_f32 v41, v41, v251
    v_cvt_pk_bf16_f32 v245, v250, v251
    v_add_f32 v40, v40, v252
    v_add_f32 v41, v41, v253
    v_cvt_pk_bf16_f32 v246, v252, v253
    v_add_f32 v40, v40, v254
    v_add_f32 v41, v41, v255
    v_cvt_pk_bf16_f32 v247, v254, v255
    s_waitcnt lgkmcnt(0)
    v_mfma_f32_32x32x16_bf16 v[128:143], a[92:95], v[172:175], v[128:143]
    v_add_f32 v44, v44, v45
    v_add_f32 v46, v46, v47
    v_add_f32 v44, v44, v46
    v_rcp_f32 v30, v44
    s_nop 0
    v_mov_b32 v31, v30
    v_add_f32 v48, v48, v49
    v_add_f32 v50, v50, v51
    v_add_f32 v48, v48, v50
    v_rcp_f32 v32, v48
    s_nop 0
    v_mov_b32 v33, v32
    v_add_f32 v40, v40, v41
    v_mov_b32 v41, v40
    s_nop 1
    v_permlane32_swap_b32 v41, v40
    v_add_f32 v40, v40, v41
    v_subrev_u32 v20, 30720, v23
    ds_write_b32 v20, v40
    ds_write_b128 v17, v[192:195] offset:0
    ds_write_b128 v17, v[196:199] offset:1024
    ds_write_b128 v17, v[208:211] offset:2048
    ds_write_b128 v17, v[212:215] offset:3072
    ds_write_b128 v17, v[224:227] offset:4096
    ds_write_b128 v17, v[228:231] offset:5120
    ds_write_b128 v17, v[240:243] offset:6144
    ds_write_b128 v17, v[244:247] offset:7168
    s_waitcnt vmcnt(11) lgkmcnt(0)
    s_barrier
    ds_read_b64_tr_b16 a[96:97], v8 offset:49152
    ds_read_b64_tr_b16 a[98:99], v8 offset:51200
    ds_read_b64_tr_b16 a[100:101], v8 offset:53248
    ds_read_b64_tr_b16 a[102:103], v8 offset:55296
    ds_read_b64_tr_b16 a[104:105], v8 offset:57344
    ds_read_b64_tr_b16 a[106:107], v8 offset:59392
    ds_read_b64_tr_b16 a[108:109], v8 offset:61440
    ds_read_b64_tr_b16 a[110:111], v8 offset:63488
    ds_read_b128 v[80:83], v21 offset:6144
    ds_read_b128 v[84:87], v21 offset:14336
    ds_read_b128 v[88:91], v21 offset:22528
    ds_read_b128 v[92:95], v21 offset:30720
    ds_read_b128 v[144:147], v16 offset:6144
    ds_read_b128 v[148:151], v16 offset:14336
    ds_read_b128 v[152:155], v16 offset:22528
    ds_read_b128 v[156:159], v16 offset:30720
    s_add_u32 s49, s86, 65536
    s_add_u32 m0, s47, 32768
    s_nop 0
    buffer_load_dwordx4 v4, s[68:71], s49 offen offset:0 lds
    buffer_load_dwordx4 v5, s[68:71], s49 offen offset:1024 lds
    buffer_load_dwordx4 v6, s[68:71], s49 offen offset:2048 lds
    buffer_load_dwordx4 v7, s[68:71], s49 offen offset:3072 lds
    v_subrev_u32 v20, 30720, v24
    ds_read_b128 v[52:55], v20
    s_waitcnt lgkmcnt(8)
    v_mfma_f32_32x32x16_bf16 v[64:79], a[96:99], v[80:83], v[64:79]
    s_waitcnt lgkmcnt(7)
    v_mfma_f32_32x32x16_bf16 v[64:79], a[100:103], v[84:87], v[64:79]
    s_waitcnt lgkmcnt(6)
    v_mfma_f32_32x32x16_bf16 v[64:79], a[104:107], v[88:91], v[64:79]
    s_waitcnt lgkmcnt(5)
    v_mfma_f32_32x32x16_bf16 v[64:79], a[108:111], v[92:95], v[64:79]
    s_waitcnt vmcnt(11) lgkmcnt(0)
    s_barrier
    ds_read_b64_tr_b16 a[112:113], v42 offset:32768
    ds_read_b64_tr_b16 a[114:115], v42 offset:34816
    ds_read_b64_tr_b16 a[116:117], v42 offset:36864
    ds_read_b64_tr_b16 a[118:119], v42 offset:38912
    ds_read_b64_tr_b16 a[120:121], v42 offset:40960
    ds_read_b64_tr_b16 a[122:123], v42 offset:43008
    ds_read_b64_tr_b16 a[124:125], v42 offset:45056
    ds_read_b64_tr_b16 a[126:127], v42 offset:47104
    ds_read_b128 v[96:99], v21 offset:7168
    ds_read_b128 v[100:103], v21 offset:15360
    ds_read_b128 v[104:107], v21 offset:23552
    ds_read_b128 v[108:111], v21 offset:31744
    ds_read_b128 v[160:163], v16 offset:7168
    ds_read_b128 v[164:167], v16 offset:15360
    ds_read_b128 v[168:171], v16 offset:23552
    ds_read_b128 v[172:175], v16 offset:31744
    v_mfma_f32_32x32x16_bf16 v[128:143], a[96:99], v[144:147], v[128:143]
    ds_read_b128 v[192:195], v18 offset:0
    ds_read_b128 v[196:199], v18 offset:8192
    ds_read_b128 v[200:203], v18 offset:16384
    ds_read_b128 v[204:207], v18 offset:24576
    v_mfma_f32_32x32x16_bf16 v[128:143], a[100:103], v[148:151], v[128:143]
    ds_read_b128 v[208:211], v18 offset:1024
    ds_read_b128 v[212:215], v18 offset:9216
    ds_read_b128 v[216:219], v18 offset:17408
    v_mfma_f32_32x32x16_bf16 v[128:143], a[104:107], v[152:155], v[128:143]
    ds_read_b128 v[220:223], v18 offset:25600
    s_add_u32 s49, s86, 131072
    s_add_u32 m0, s47, 49152
    s_nop 0
    buffer_load_dwordx4 v4, s[68:71], s49 offen offset:0 lds
    buffer_load_dwordx4 v5, s[68:71], s49 offen offset:1024 lds
    v_mfma_f32_32x32x16_bf16 v[128:143], a[108:111], v[156:159], v[128:143]
    buffer_load_dwordx4 v6, s[68:71], s49 offen offset:2048 lds
    buffer_load_dwordx4 v7, s[68:71], s49 offen offset:3072 lds
    s_waitcnt lgkmcnt(15)
    v_mfma_f32_32x32x16_bf16 v[64:79], a[112:115], v[96:99], v[64:79]
    s_waitcnt lgkmcnt(14)
    v_mfma_f32_32x32x16_bf16 v[64:79], a[116:119], v[100:103], v[64:79]
    s_waitcnt lgkmcnt(13)
    v_mfma_f32_32x32x16_bf16 v[64:79], a[120:123], v[104:107], v[64:79]
    s_waitcnt lgkmcnt(12)
    v_mfma_f32_32x32x16_bf16 v[64:79], a[124:127], v[108:111], v[64:79]
    s_waitcnt lgkmcnt(0)
    s_barrier
    v_mfma_f32_32x32x16_bf16 v[128:143], a[112:115], v[160:163], v[128:143]
    s_add_u32 s49, s86, 196608
    s_add_u32 m0, s47, 98304
    s_nop 0
    buffer_load_dwordx4 v4, s[68:71], s49 offen offset:0 lds
    buffer_load_dwordx4 v5, s[68:71], s49 offen offset:1024 lds
    buffer_load_dwordx4 v6, s[68:71], s49 offen offset:2048 lds
    buffer_load_dwordx4 v7, s[68:71], s49 offen offset:3072 lds
    v_mfma_f32_32x32x16_bf16 v[128:143], a[116:119], v[164:167], v[128:143]
    s_add_u32 s49, s86, 262144
    s_add_u32 m0, s47, 0
    s_nop 0
    buffer_load_dwordx4 v4, s[68:71], s49 offen offset:0 lds
    buffer_load_dwordx4 v5, s[68:71], s49 offen offset:1024 lds
    buffer_load_dwordx4 v6, s[68:71], s49 offen offset:2048 lds
    v_mfma_f32_32x32x16_bf16 v[128:143], a[120:123], v[168:171], v[128:143]
    buffer_load_dwordx4 v7, s[68:71], s49 offen offset:3072 lds
    v_add_f32 v52, v52, v53
    v_add_f32 v54, v54, v55
    v_mfma_f32_32x32x16_bf16 v[128:143], a[124:127], v[172:175], v[128:143]
    v_add_f32 v52, v52, v54
    v_rcp_f32 v34, v52
    s_nop 0
    v_mov_b32 v35, v34
    v_mfma_f32_32x32x16_bf16 v[176:191], a[0:3], v[192:195], 0
    v_mul_f32 v64, v64, v30
    v_mul_f32 v65, v65, v30
    v_mul_f32 v66, v66, v30
    v_mul_f32 v67, v67, v30
    v_mfma_f32_32x32x16_bf16 v[176:191], a[4:7], v[196:199], v[176:191]
    v_mul_f32 v68, v68, v30
    v_mul_f32 v69, v69, v30
    v_mul_f32 v70, v70, v30
    v_mfma_f32_32x32x16_bf16 v[176:191], a[8:11], v[200:203], v[176:191]
    v_mul_f32 v71, v71, v30
    v_mul_f32 v72, v72, v30
    v_mul_f32 v73, v73, v30
    v_mul_f32 v74, v74, v30
    v_mfma_f32_32x32x16_bf16 v[176:191], a[12:15], v[204:207], v[176:191]
    v_mul_f32 v75, v75, v30
    v_mul_f32 v76, v76, v30
    v_mul_f32 v77, v77, v30
    v_mfma_f32_32x32x16_bf16 v[176:191], a[16:19], v[208:211], v[176:191]
    ds_read_b128 v[192:195], v18 offset:2048
    ds_read_b128 v[196:199], v18 offset:10240
    ds_read_b128 v[200:203], v18 offset:18432
    ds_read_b128 v[204:207], v18 offset:26624
    v_mul_f32 v78, v78, v30
    v_mul_f32 v79, v79, v30
    v_mfma_f32_32x32x16_bf16 v[176:191], a[20:23], v[212:215], v[176:191]
    v_cvt_pk_bf16_f32 v64, v64, v65
    v_cvt_pk_bf16_f32 v65, v66, v67
    v_cvt_pk_bf16_f32 v66, v68, v69
    v_cvt_pk_bf16_f32 v67, v70, v71
    buffer_store_dwordx4 v[64:67], v28, s[36:39], s58 offen offset:0 sc1
    v_mfma_f32_32x32x16_bf16 v[176:191], a[24:27], v[216:219], v[176:191]
    v_cvt_pk_bf16_f32 v68, v72, v73
    v_cvt_pk_bf16_f32 v69, v74, v75
    v_cvt_pk_bf16_f32 v70, v76, v77
    v_cvt_pk_bf16_f32 v71, v78, v79
    buffer_store_dwordx4 v[68:71], v28, s[36:39], s58 offen offset:1024 sc1
    v_mfma_f32_32x32x16_bf16 v[176:191], a[28:31], v[220:223], v[176:191]
    s_add_u32 s49, s86, 327680
    s_add_u32 m0, s47, 16384
    s_nop 0
    buffer_load_dwordx4 v4, s[68:71], s49 offen offset:0 lds
    buffer_load_dwordx4 v5, s[68:71], s49 offen offset:1024 lds
    buffer_load_dwordx4 v6, s[68:71], s49 offen offset:2048 lds
    buffer_load_dwordx4 v7, s[68:71], s49 offen offset:3072 lds
    s_waitcnt lgkmcnt(3)
    v_mfma_f32_32x32x16_bf16 v[176:191], a[32:35], v[192:195], v[176:191]
    ds_read_b128 v[208:211], v18 offset:3072
    ds_read_b128 v[212:215], v18 offset:11264
    ds_read_b128 v[216:219], v18 offset:19456
    ds_read_b128 v[220:223], v18 offset:27648
    v_mul_f32 v128, v128, v32
    s_waitcnt lgkmcnt(6)
    v_mfma_f32_32x32x16_bf16 v[176:191], a[36:39], v[196:199], v[176:191]
    v_mul_f32 v129, v129, v32
    v_mul_f32 v130, v130, v32
    v_mul_f32 v131, v131, v32
    v_mul_f32 v132, v132, v32
    v_mul_f32 v133, v133, v32
    s_waitcnt lgkmcnt(5)
    v_mfma_f32_32x32x16_bf16 v[176:191], a[40:43], v[200:203], v[176:191]
    v_mul_f32 v134, v134, v32
    v_mul_f32 v135, v135, v32
    v_mul_f32 v136, v136, v32
    v_mul_f32 v137, v137, v32
    v_mul_f32 v138, v138, v32
    s_waitcnt lgkmcnt(4)
    v_mfma_f32_32x32x16_bf16 v[176:191], a[44:47], v[204:207], v[176:191]
    v_mul_f32 v139, v139, v32
    v_mul_f32 v140, v140, v32
    v_mul_f32 v141, v141, v32
    v_mul_f32 v142, v142, v32
    v_mul_f32 v143, v143, v32
    s_waitcnt lgkmcnt(3)
    v_mfma_f32_32x32x16_bf16 v[176:191], a[48:51], v[208:211], v[176:191]
    ds_read_b128 v[192:195], v18 offset:4096
    ds_read_b128 v[196:199], v18 offset:12288
    ds_read_b128 v[200:203], v18 offset:20480
    ds_read_b128 v[204:207], v18 offset:28672
    v_cvt_pk_bf16_f32 v128, v128, v129
    s_waitcnt lgkmcnt(6)
    v_mfma_f32_32x32x16_bf16 v[176:191], a[52:55], v[212:215], v[176:191]
    v_cvt_pk_bf16_f32 v129, v130, v131
    v_cvt_pk_bf16_f32 v130, v132, v133
    v_cvt_pk_bf16_f32 v131, v134, v135
    buffer_store_dwordx4 v[128:131], v28, s[36:39], s59 offen offset:0 sc1
    v_cvt_pk_bf16_f32 v132, v136, v137
    s_waitcnt lgkmcnt(5)
    v_mfma_f32_32x32x16_bf16 v[176:191], a[56:59], v[216:219], v[176:191]
    v_cvt_pk_bf16_f32 v133, v138, v139
    v_cvt_pk_bf16_f32 v134, v140, v141
    v_cvt_pk_bf16_f32 v135, v142, v143
    buffer_store_dwordx4 v[132:135], v28, s[36:39], s59 offen offset:1024 sc1
    s_add_u32 s49, s86, 393216
    s_add_u32 m0, s47, 114688
    s_nop 0
    buffer_load_dwordx4 v4, s[68:71], s49 offen offset:0 lds
    s_waitcnt lgkmcnt(4)
    v_mfma_f32_32x32x16_bf16 v[176:191], a[60:63], v[220:223], v[176:191]
    buffer_load_dwordx4 v5, s[68:71], s49 offen offset:1024 lds
    buffer_load_dwordx4 v6, s[68:71], s49 offen offset:2048 lds
    buffer_load_dwordx4 v7, s[68:71], s49 offen offset:3072 lds
    s_waitcnt lgkmcnt(3)
    v_mfma_f32_32x32x16_bf16 v[176:191], a[64:67], v[192:195], v[176:191]
    ds_read_b128 v[208:211], v18 offset:5120
    ds_read_b128 v[212:215], v18 offset:13312
    ds_read_b128 v[216:219], v18 offset:21504
    ds_read_b128 v[220:223], v18 offset:29696
    s_add_u32 s49, s86, 458752
    s_add_u32 m0, s47, 131072
    s_nop 0
    buffer_load_dwordx4 v4, s[68:71], s49 offen offset:0 lds
    s_waitcnt lgkmcnt(6)
    v_mfma_f32_32x32x16_bf16 v[176:191], a[68:71], v[196:199], v[176:191]
    buffer_load_dwordx4 v5, s[68:71], s49 offen offset:1024 lds
    buffer_load_dwordx4 v6, s[68:71], s49 offen offset:2048 lds
    buffer_load_dwordx4 v7, s[68:71], s49 offen offset:3072 lds
    s_waitcnt lgkmcnt(5)
    v_mfma_f32_32x32x16_bf16 v[176:191], a[72:75], v[200:203], v[176:191]
    s_waitcnt vmcnt(32)
    ds_read_b64_tr_b16 a[128:129], v13 offset:16384
    ds_read_b64_tr_b16 a[130:131], v13 offset:16896
    ds_read_b64_tr_b16 a[132:133], v14 offset:16384
    ds_read_b64_tr_b16 a[134:135], v14 offset:16896
    s_waitcnt lgkmcnt(8)
    v_mfma_f32_32x32x16_bf16 v[176:191], a[76:79], v[204:207], v[176:191]
    ds_read_b64_tr_b16 a[136:137], v13 offset:18432
    ds_read_b64_tr_b16 a[138:139], v13 offset:18944
    ds_read_b64_tr_b16 a[140:141], v14 offset:18432
    ds_read_b64_tr_b16 a[142:143], v14 offset:18944
    s_waitcnt lgkmcnt(11)
    v_mfma_f32_32x32x16_bf16 v[176:191], a[80:83], v[208:211], v[176:191]
    ds_read_b128 v[192:195], v18 offset:6144
    ds_read_b128 v[196:199], v18 offset:14336
    ds_read_b128 v[200:203], v18 offset:22528
    ds_read_b128 v[204:207], v18 offset:30720
    s_waitcnt lgkmcnt(14)
    v_mfma_f32_32x32x16_bf16 v[176:191], a[84:87], v[212:215], v[176:191]
    s_waitcnt vmcnt(28)
    ds_read_b64_tr_b16 a[144:145], v9 offset:32768
    ds_read_b64_tr_b16 a[146:147], v9 offset:33280
    s_waitcnt lgkmcnt(15)
    v_mfma_f32_32x32x16_bf16 v[176:191], a[88:91], v[216:219], v[176:191]
    ds_read_b64_tr_b16 a[148:149], v10 offset:32768
    ds_read_b64_tr_b16 a[150:151], v10 offset:33280
    ds_read_b64_tr_b16 a[152:153], v9 offset:34816
    s_waitcnt lgkmcnt(15)
    v_mfma_f32_32x32x16_bf16 v[176:191], a[92:95], v[220:223], v[176:191]
    ds_read_b64_tr_b16 a[154:155], v9 offset:35328
    ds_read_b64_tr_b16 a[156:157], v10 offset:34816
    ds_read_b64_tr_b16 a[158:159], v10 offset:35328
    s_waitcnt lgkmcnt(11)
    v_mfma_f32_32x32x16_bf16 v[176:191], a[96:99], v[192:195], v[176:191]
    ds_read_b128 v[208:211], v18 offset:7168
    ds_read_b128 v[212:215], v18 offset:15360
    ds_read_b128 v[216:219], v18 offset:23552
    ds_read_b128 v[220:223], v18 offset:31744
    s_waitcnt vmcnt(24)
    ds_read_b64_tr_b16 a[160:161], v9 offset:49152
    s_waitcnt lgkmcnt(15)
    v_mfma_f32_32x32x16_bf16 v[176:191], a[100:103], v[196:199], v[176:191]
    ds_read_b64_tr_b16 a[162:163], v9 offset:49664
    ds_read_b64_tr_b16 a[164:165], v10 offset:49152
    ds_read_b64_tr_b16 a[166:167], v10 offset:49664
    ds_read_b64_tr_b16 a[168:169], v9 offset:51200
    ds_read_b64_tr_b16 a[170:171], v9 offset:51712
    ds_read_b64_tr_b16 a[172:173], v10 offset:51200
    s_waitcnt lgkmcnt(15)
    v_mfma_f32_32x32x16_bf16 v[176:191], a[104:107], v[200:203], v[176:191]
    ds_read_b64_tr_b16 a[174:175], v10 offset:51712
    s_waitcnt lgkmcnt(0)
    s_add_u32 s49, s86, 524288
    s_add_u32 m0, s47, 147456
    s_nop 0
    buffer_load_dwordx4 v4, s[68:71], s49 offen offset:0 lds
    buffer_load_dwordx4 v5, s[68:71], s49 offen offset:1024 lds
    buffer_load_dwordx4 v6, s[68:71], s49 offen offset:2048 lds
    buffer_load_dwordx4 v7, s[68:71], s49 offen offset:3072 lds
    v_mfma_f32_32x32x16_bf16 v[176:191], a[108:111], v[204:207], v[176:191]
    s_add_u32 s49, s86, 589824
    s_add_u32 m0, s47, 32768
    s_nop 0
    buffer_load_dwordx4 v4, s[68:71], s49 offen offset:0 lds
    buffer_load_dwordx4 v5, s[68:71], s49 offen offset:1024 lds
    buffer_load_dwordx4 v6, s[68:71], s49 offen offset:2048 lds
    buffer_load_dwordx4 v7, s[68:71], s49 offen offset:3072 lds
    v_readfirstlane_b32 s91, v19
    s_movk_i32 s92, 20000
    s_cmp_eq_u32 s91, 32
    s_cbranch_scc1 L_cnt_ok
L_cnt:
    buffer_load_dword v19, off, s[76:79], s83 sc1
    s_waitcnt vmcnt(0)
    v_readfirstlane_b32 s91, v19
    s_cmp_eq_u32 s91, 32
    s_cbranch_scc1 L_cnt_ok
    s_sleep 4
    s_sub_u32 s92, s92, 1
    s_cmp_lg_u32 s92, 0
    s_cbranch_scc1 L_cnt
L_cnt_ok:
    v_mfma_f32_32x32x16_bf16 v[176:191], a[112:115], v[208:211], v[176:191]
    s_waitcnt vmcnt(28)
    ds_read_b64_tr_b16 a[176:177], v11 offset:32768
    ds_read_b64_tr_b16 a[178:179], v11 offset:33280
    v_mfma_f32_32x32x16_bf16 v[176:191], a[116:119], v[212:215], v[176:191]
    ds_read_b64_tr_b16 a[180:181], v12 offset:32768
    ds_read_b64_tr_b16 a[182:183], v12 offset:33280
    v_mfma_f32_32x32x16_bf16 v[176:191], a[120:123], v[216:219], v[176:191]
    ds_read_b64_tr_b16 a[184:185], v11 offset:34816
    ds_read_b64_tr_b16 a[186:187], v11 offset:35328
    v_mfma_f32_32x32x16_bf16 v[176:191], a[124:127], v[220:223], v[176:191]
    ds_read_b64_tr_b16 a[188:189], v12 offset:34816
    ds_read_b64_tr_b16 a[190:191], v12 offset:35328
    s_nop 9
    v_mul_f32 v176, v176, v34
    v_mul_f32 v177, v177, v34
    v_mul_f32 v178, v178, v34
    v_mul_f32 v179, v179, v34
    v_mul_f32 v180, v180, v34
    v_mul_f32 v181, v181, v34
    v_mul_f32 v182, v182, v34
    v_mul_f32 v183, v183, v34
    v_mul_f32 v184, v184, v34
    v_mul_f32 v185, v185, v34
    v_mul_f32 v186, v186, v34
    v_mul_f32 v187, v187, v34
    v_mul_f32 v188, v188, v34
    v_mul_f32 v189, v189, v34
    v_mul_f32 v190, v190, v34
    v_mul_f32 v191, v191, v34
    v_cvt_pk_bf16_f32 v176, v176, v177
    v_cvt_pk_bf16_f32 v177, v178, v179
    v_cvt_pk_bf16_f32 v178, v180, v181
    v_cvt_pk_bf16_f32 v179, v182, v183
    buffer_store_dwordx4 v[176:179], v28, s[36:39], s81 offen offset:0 sc1
    v_cvt_pk_bf16_f32 v180, v184, v185
    v_cvt_pk_bf16_f32 v181, v186, v187
    v_cvt_pk_bf16_f32 v182, v188, v189
    v_cvt_pk_bf16_f32 v183, v190, v191
    buffer_store_dwordx4 v[180:183], v28, s[36:39], s81 offen offset:1024 sc1
    s_add_u32 s93, s87, 0
    buffer_load_dwordx4 v[192:195], v21, s[36:39], s93 offen offset:0 sc1
    buffer_load_dwordx4 v[196:199], v21, s[36:39], s93 offen offset:1024 sc1
    buffer_load_dwordx4 v[200:203], v21, s[36:39], s93 offen offset:2048 sc1
    buffer_load_dwordx4 v[204:207], v21, s[36:39], s93 offen offset:3072 sc1
    s_add_u32 s93, s87, 4096
    buffer_load_dwordx4 v[208:211], v21, s[36:39], s93 offen offset:0 sc1
    buffer_load_dwordx4 v[212:215], v21, s[36:39], s93 offen offset:1024 sc1
    buffer_load_dwordx4 v[216:219], v21, s[36:39], s93 offen offset:2048 sc1
    buffer_load_dwordx4 v[220:223], v21, s[36:39], s93 offen offset:3072 sc1
    s_waitcnt vmcnt(34)
    ds_read_b64_tr_b16 a[192:193], v9 offset:0
    ds_read_b64_tr_b16 a[194:195], v9 offset:512
    ds_read_b64_tr_b16 a[196:197], v10 offset:0
    ds_read_b64_tr_b16 a[198:199], v10 offset:512
    ds_read_b64_tr_b16 a[200:201], v9 offset:2048
    ds_read_b64_tr_b16 a[202:203], v9 offset:2560
    ds_read_b64_tr_b16 a[204:205], v10 offset:2048
    ds_read_b64_tr_b16 a[206:207], v10 offset:2560
    s_waitcnt vmcnt(28)
    ds_read_b64_tr_b16 a[208:209], v9 offset:16384
    ds_read_b64_tr_b16 a[210:211], v9 offset:16896
    ds_read_b64_tr_b16 a[212:213], v10 offset:16384
    ds_read_b64_tr_b16 a[214:215], v10 offset:16896
    ds_read_b64_tr_b16 a[216:217], v9 offset:18432
    ds_read_b64_tr_b16 a[218:219], v9 offset:18944
    ds_read_b64_tr_b16 a[220:221], v10 offset:18432
    ds_read_b64_tr_b16 a[222:223], v10 offset:18944
    s_waitcnt lgkmcnt(0)
    s_add_u32 s49, s86, 655360
    s_add_u32 m0, s47, 49152
    s_nop 0
    buffer_load_dwordx4 v4, s[68:71], s49 offen offset:0 lds
    buffer_load_dwordx4 v5, s[68:71], s49 offen offset:1024 lds
    buffer_load_dwordx4 v6, s[68:71], s49 offen offset:2048 lds
    buffer_load_dwordx4 v7, s[68:71], s49 offen offset:3072 lds
    s_add_u32 s49, s86, 720896
    s_add_u32 m0, s47, 98304
    s_nop 0
    buffer_load_dwordx4 v4, s[68:71], s49 offen offset:0 lds
    buffer_load_dwordx4 v5, s[68:71], s49 offen offset:1024 lds
    buffer_load_dwordx4 v6, s[68:71], s49 offen offset:2048 lds
    buffer_load_dwordx4 v7, s[68:71], s49 offen offset:3072 lds
    s_add_u32 s49, s86, 786432
    s_add_u32 m0, s47, 0
    s_nop 0
    buffer_load_dwordx4 v4, s[68:71], s49 offen offset:0 lds
    buffer_load_dwordx4 v5, s[68:71], s49 offen offset:1024 lds
    buffer_load_dwordx4 v6, s[68:71], s49 offen offset:2048 lds
    buffer_load_dwordx4 v7, s[68:71], s49 offen offset:3072 lds
    s_add_u32 s49, s86, 851968
    s_add_u32 m0, s47, 16384
    s_nop 0
    buffer_load_dwordx4 v4, s[68:71], s49 offen offset:0 lds
    buffer_load_dwordx4 v5, s[68:71], s49 offen offset:1024 lds
    buffer_load_dwordx4 v6, s[68:71], s49 offen offset:2048 lds
    buffer_load_dwordx4 v7, s[68:71], s49 offen offset:3072 lds
    s_add_u32 s93, s87, 24576
    buffer_load_dwordx4 v[224:227], v21, s[36:39], s93 offen offset:0 sc1
    buffer_load_dwordx4 v[228:231], v21, s[36:39], s93 offen offset:1024 sc1
    buffer_load_dwordx4 v[232:235], v21, s[36:39], s93 offen offset:2048 sc1
    buffer_load_dwordx4 v[236:239], v21, s[36:39], s93 offen offset:3072 sc1
    s_add_u32 s93, s87, 28672
    buffer_load_dwordx4 v[240:243], v21, s[36:39], s93 offen offset:0 sc1
    buffer_load_dwordx4 v[244:247], v21, s[36:39], s93 offen offset:1024 sc1
    buffer_load_dwordx4 v[248:251], v21, s[36:39], s93 offen offset:2048 sc1
    buffer_load_dwordx4 v[252:255], v21, s[36:39], s93 offen offset:3072 sc1
    s_waitcnt vmcnt(46)
    ds_read_b64_tr_b16 a[224:225], v11 offset:49152
    ds_read_b64_tr_b16 a[226:227], v11 offset:49664
    ds_read_b64_tr_b16 a[228:229], v12 offset:49152
    ds_read_b64_tr_b16 a[230:231], v12 offset:49664
    ds_read_b64_tr_b16 a[232:233], v11 offset:51200
    ds_read_b64_tr_b16 a[234:235], v11 offset:51712
    ds_read_b64_tr_b16 a[236:237], v12 offset:51200
    ds_read_b64_tr_b16 a[238:239], v12 offset:51712
    s_waitcnt vmcnt(42)
    ds_read_b64_tr_b16 a[240:241], v13 offset:0
    ds_read_b64_tr_b16 a[242:243], v13 offset:512
    ds_read_b64_tr_b16 a[244:245], v14 offset:0
    ds_read_b64_tr_b16 a[246:247], v14 offset:512
    ds_read_b64_tr_b16 a[248:249], v13 offset:2048
    ds_read_b64_tr_b16 a[250:251], v13 offset:2560
    ds_read_b64_tr_b16 a[252:253], v14 offset:2048
    ds_read_b64_tr_b16 a[254:255], v14 offset:2560
    s_waitcnt lgkmcnt(0)
    s_add_u32 s49, s86, 917504
    s_add_u32 m0, s47, 114688
    s_nop 0
    buffer_load_dwordx4 v4, s[68:71], s49 offen offset:0 lds
    buffer_load_dwordx4 v5, s[68:71], s49 offen offset:1024 lds
    buffer_load_dwordx4 v6, s[68:71], s49 offen offset:2048 lds
    buffer_load_dwordx4 v7, s[68:71], s49 offen offset:3072 lds
    s_add_u32 s49, s86, 983040
    s_add_u32 m0, s47, 131072
    s_nop 0
    buffer_load_dwordx4 v4, s[68:71], s49 offen offset:0 lds
    buffer_load_dwordx4 v5, s[68:71], s49 offen offset:1024 lds
    buffer_load_dwordx4 v6, s[68:71], s49 offen offset:2048 lds
    buffer_load_dwordx4 v7, s[68:71], s49 offen offset:3072 lds
    s_add_u32 s93, s87, 8192
    buffer_load_dwordx4 v[96:99], v21, s[36:39], s93 offen offset:0 sc1
    buffer_load_dwordx4 v[100:103], v21, s[36:39], s93 offen offset:1024 sc1
    buffer_load_dwordx4 v[104:107], v21, s[36:39], s93 offen offset:2048 sc1
    buffer_load_dwordx4 v[108:111], v21, s[36:39], s93 offen offset:3072 sc1
    s_add_u32 s93, s87, 12288
    buffer_load_dwordx4 v[112:115], v21, s[36:39], s93 offen offset:0 sc1
    buffer_load_dwordx4 v[116:119], v21, s[36:39], s93 offen offset:1024 sc1
    buffer_load_dwordx4 v[120:123], v21, s[36:39], s93 offen offset:2048 sc1
    buffer_load_dwordx4 v[124:127], v21, s[36:39], s93 offen offset:3072 sc1
    s_lshl_b32 s82, s84, 10
    v_add_u32 v16, s82, v22
    v_xor_b32 v17, 0x400, v16
    s_waitcnt vmcnt(47)
    v_max3_u32 v20, v192, v193, v194
    v_max_u32 v20, v20, v195
    s_waitcnt vmcnt(46)
    v_max3_u32 v20, v196, v197, v20
    v_max3_u32 v20, v198, v199, v20
    s_waitcnt vmcnt(45)
    v_max3_u32 v20, v200, v201, v20
    v_max3_u32 v20, v202, v203, v20
    s_waitcnt vmcnt(44)
    v_max3_u32 v20, v204, v205, v20
    v_max3_u32 v20, v206, v207, v20
    v_cmp_eq_u32 vcc, -1, v20
    s_cbranch_vccnz L_slow0
L_back0:
    v_mfma_f32_32x32x16_bf16 v[64:79], a[128:131], v[192:195], 0
    v_mfma_f32_32x32x16_bf16 v[80:95], a[132:135], v[192:195], 0
    s_add_u32 s93, s87, 32768
    buffer_load_dwordx4 v[192:195], v21, s[36:39], s93 offen offset:0 sc1
    v_mfma_f32_32x32x16_bf16 v[64:79], a[136:139], v[196:199], v[64:79]
    v_mfma_f32_32x32x16_bf16 v[80:95], a[140:143], v[196:199], v[80:95]
    buffer_load_dwordx4 v[196:199], v21, s[36:39], s93 offen offset:1024 sc1
    s_waitcnt vmcnt(45)
    v_max3_u32 v20, v208, v209, v210
    v_max_u32 v20, v20, v211
    s_waitcnt vmcnt(44)
    v_max3_u32 v20, v212, v213, v20
    v_mfma_f32_32x32x16_bf16 v[64:79], a[144:147], v[200:203], v[64:79]
    v_max3_u32 v20, v214, v215, v20
    s_waitcnt vmcnt(43)
    v_max3_u32 v20, v216, v217, v20
    v_mfma_f32_32x32x16_bf16 v[80:95], a[148:151], v[200:203], v[80:95]
    buffer_load_dwordx4 v[200:203], v21, s[36:39], s93 offen offset:2048 sc1
    v_max3_u32 v20, v218, v219, v20
    s_waitcnt vmcnt(43)
    v_max3_u32 v20, v220, v221, v20
    v_mfma_f32_32x32x16_bf16 v[64:79], a[152:155], v[204:207], v[64:79]
    v_max3_u32 v20, v222, v223, v20
    v_cmp_eq_u32 vcc, -1, v20
    v_mfma_f32_32x32x16_bf16 v[80:95], a[156:159], v[204:207], v[80:95]
    buffer_load_dwordx4 v[204:207], v21, s[36:39], s93 offen offset:3072 sc1
    s_cbranch_vccnz L_slow1
L_back1:
    v_mfma_f32_32x32x16_bf16 v[64:79], a[160:163], v[208:211], v[64:79]
    v_mfma_f32_32x32x16_bf16 v[80:95], a[164:167], v[208:211], v[80:95]
    s_add_u32 s93, s87, 36864
    buffer_load_dwordx4 v[208:211], v21, s[36:39], s93 offen offset:0 sc1
    v_mfma_f32_32x32x16_bf16 v[64:79], a[168:171], v[212:215], v[64:79]
    v_mfma_f32_32x32x16_bf16 v[80:95], a[172:175], v[212:215], v[80:95]
    buffer_load_dwordx4 v[212:215], v21, s[36:39], s93 offen offset:1024 sc1
    s_waitcnt vmcnt(29)
    v_max3_u32 v20, v224, v225, v226
    v_max_u32 v20, v20, v227
    s_waitcnt vmcnt(28)
    v_max3_u32 v20, v228, v229, v20
    v_mfma_f32_32x32x16_bf16 v[64:79], a[176:179], v[216:219], v[64:79]
    v_max3_u32 v20, v230, v231, v20
    s_waitcnt vmcnt(27)
    v_max3_u32 v20, v232, v233, v20
    v_mfma_f32_32x32x16_bf16 v[80:95], a[180:183], v[216:219], v[80:95]
    buffer_load_dwordx4 v[216:219], v21, s[36:39], s93 offen offset:2048 sc1
    v_max3_u32 v20, v234, v235, v20
    s_waitcnt vmcnt(27)
    v_max3_u32 v20, v236, v237, v20
    v_mfma_f32_32x32x16_bf16 v[64:79], a[184:187], v[220:223], v[64:79]
    v_max3_u32 v20, v238, v239, v20
    v_cmp_eq_u32 vcc, -1, v20
    v_mfma_f32_32x32x16_bf16 v[80:95], a[188:191], v[220:223], v[80:95]
    buffer_load_dwordx4 v[220:223], v21, s[36:39], s93 offen offset:3072 sc1
    s_cbranch_vccnz L_slow2
L_back2:
    v_mfma_f32_32x32x16_bf16 v[64:79], a[192:195], v[224:227], v[64:79]
    ds_read_b64_tr_b16 a[0:1], v13 offset:16384
    ds_read_b64_tr_b16 a[2:3], v13 offset:16896
    v_mfma_f32_32x32x16_bf16 v[80:95], a[196:199], v[224:227], v[80:95]
    s_add_u32 s93, s87, 49152
    buffer_load_dwordx4 v[224:227], v21, s[36:39], s93 offen offset:0 sc1
    ds_read_b64_tr_b16 a[4:5], v14 offset:16384
    ds_read_b64_tr_b16 a[6:7], v14 offset:16896
    ds_read_b64_tr_b16 a[8:9], v13 offset:18432
    v_mfma_f32_32x32x16_bf16 v[64:79], a[200:203], v[228:231], v[64:79]
    ds_read_b64_tr_b16 a[10:11], v13 offset:18944
    ds_read_b64_tr_b16 a[12:13], v14 offset:18432
    ds_read_b64_tr_b16 a[14:15], v14 offset:18944
    v_mfma_f32_32x32x16_bf16 v[80:95], a[204:207], v[228:231], v[80:95]
    buffer_load_dwordx4 v[228:231], v21, s[36:39], s93 offen offset:1024 sc1
    ds_read_b64_tr_b16 a[16:17], v9 offset:32768
    ds_read_b64_tr_b16 a[18:19], v9 offset:33280
    ds_read_b64_tr_b16 a[20:21], v10 offset:32768
    ds_read_b64_tr_b16 a[22:23], v10 offset:33280
    v_mfma_f32_32x32x16_bf16 v[64:79], a[208:211], v[232:235], v[64:79]
    ds_read_b64_tr_b16 a[24:25], v9 offset:34816
    ds_read_b64_tr_b16 a[26:27], v9 offset:35328
    ds_read_b64_tr_b16 a[28:29], v10 offset:34816
    ds_read_b64_tr_b16 a[30:31], v10 offset:35328
    v_mfma_f32_32x32x16_bf16 v[80:95], a[212:215], v[232:235], v[80:95]
    buffer_load_dwordx4 v[232:235], v21, s[36:39], s93 offen offset:2048 sc1
    s_waitcnt vmcnt(30)
    v_max3_u32 v20, v240, v241, v242
    v_max_u32 v20, v20, v243
    s_waitcnt vmcnt(29)
    v_max3_u32 v20, v244, v245, v20
    v_max3_u32 v20, v246, v247, v20
    s_waitcnt vmcnt(28)
    v_max3_u32 v20, v248, v249, v20
    v_mfma_f32_32x32x16_bf16 v[64:79], a[216:219], v[236:239], v[64:79]
    v_max3_u32 v20, v250, v251, v20
    s_waitcnt vmcnt(27)
    v_max3_u32 v20, v252, v253, v20
    v_max3_u32 v20, v254, v255, v20
    v_cmp_eq_u32 vcc, -1, v20
    v_mfma_f32_32x32x16_bf16 v[80:95], a[220:223], v[236:239], v[80:95]
    buffer_load_dwordx4 v[236:239], v21, s[36:39], s93 offen offset:3072 sc1
    s_cbranch_vccnz L_slow3
L_back3:
    v_mfma_f32_32x32x16_bf16 v[64:79], a[224:227], v[240:243], v[64:79]
    ds_read_b64_tr_b16 a[32:33], v9 offset:49152
    ds_read_b64_tr_b16 a[34:35], v9 offset:49664
    v_mfma_f32_32x32x16_bf16 v[80:95], a[228:231], v[240:243], v[80:95]
    s_add_u32 s93, s87, 53248
    buffer_load_dwordx4 v[240:243], v21, s[36:39], s93 offen offset:0 sc1
    ds_read_b64_tr_b16 a[36:37], v10 offset:49152
    ds_read_b64_tr_b16 a[38:39], v10 offset:49664
    ds_read_b64_tr_b16 a[40:41], v9 offset:51200
    v_mfma_f32_32x32x16_bf16 v[64:79], a[232:235], v[244:247], v[64:79]
    ds_read_b64_tr_b16 a[42:43], v9 offset:51712
    ds_read_b64_tr_b16 a[44:45], v10 offset:51200
    ds_read_b64_tr_b16 a[46:47], v10 offset:51712
    v_mfma_f32_32x32x16_bf16 v[80:95], a[236:239], v[244:247], v[80:95]
    buffer_load_dwordx4 v[244:247], v21, s[36:39], s93 offen offset:1024 sc1
    ds_read_b64_tr_b16 a[48:49], v11 offset:32768
    ds_read_b64_tr_b16 a[50:51], v11 offset:33280
    ds_read_b64_tr_b16 a[52:53], v12 offset:32768
    ds_read_b64_tr_b16 a[54:55], v12 offset:33280
    v_mfma_f32_32x32x16_bf16 v[64:79], a[240:243], v[248:251], v[64:79]
    ds_read_b64_tr_b16 a[56:57], v11 offset:34816
    ds_read_b64_tr_b16 a[58:59], v11 offset:35328
    ds_read_b64_tr_b16 a[60:61], v12 offset:34816
    ds_read_b64_tr_b16 a[62:63], v12 offset:35328
    v_mfma_f32_32x32x16_bf16 v[80:95], a[244:247], v[248:251], v[80:95]
    buffer_load_dwordx4 v[248:251], v21, s[36:39], s93 offen offset:2048 sc1
    s_waitcnt vmcnt(22)
    v_max3_u32 v20, v96, v97, v98
    v_max_u32 v20, v20, v99
    s_waitcnt vmcnt(21)
    v_max3_u32 v20, v100, v101, v20
    v_max3_u32 v20, v102, v103, v20
    s_waitcnt vmcnt(20)
    v_max3_u32 v20, v104, v105, v20
    v_mfma_f32_32x32x16_bf16 v[64:79], a[248:251], v[252:255], v[64:79]
    v_max3_u32 v20, v106, v107, v20
    s_waitcnt vmcnt(19)
    v_max3_u32 v20, v108, v109, v20
    v_max3_u32 v20, v110, v111, v20
    v_cmp_eq_u32 vcc, -1, v20
    v_mfma_f32_32x32x16_bf16 v[80:95], a[252:255], v[252:255], v[80:95]
    buffer_load_dwordx4 v[252:255], v21, s[36:39], s93 offen offset:3072 sc1
    s_cbranch_vccnz L_slow4
L_back4:
    v_mfma_f32_32x32x16_bf16 v[128:143], a[128:131], v[96:99], 0
    ds_read_b64_tr_b16 a[64:65], v9 offset:0
    ds_read_b64_tr_b16 a[66:67], v9 offset:512
    v_mfma_f32_32x32x16_bf16 v[144:159], a[132:135], v[96:99], 0
    s_add_u32 s93, s87, 73728
    buffer_load_dwordx4 v[96:99], v21, s[36:39], s93 offen offset:0 sc1
    ds_read_b64_tr_b16 a[68:69], v10 offset:0
    ds_read_b64_tr_b16 a[70:71], v10 offset:512
    ds_read_b64_tr_b16 a[72:73], v9 offset:2048
    v_mfma_f32_32x32x16_bf16 v[128:143], a[136:139], v[100:103], v[128:143]
    ds_read_b64_tr_b16 a[74:75], v9 offset:2560
    ds_read_b64_tr_b16 a[76:77], v10 offset:2048
    ds_read_b64_tr_b16 a[78:79], v10 offset:2560
    v_mfma_f32_32x32x16_bf16 v[144:159], a[140:143], v[100:103], v[144:159]
    buffer_load_dwordx4 v[100:103], v21, s[36:39], s93 offen offset:1024 sc1
    ds_read_b64_tr_b16 a[80:81], v9 offset:16384
    ds_read_b64_tr_b16 a[82:83], v9 offset:16896
    ds_read_b64_tr_b16 a[84:85], v10 offset:16384
    ds_read_b64_tr_b16 a[86:87], v10 offset:16896
    v_mfma_f32_32x32x16_bf16 v[128:143], a[144:147], v[104:107], v[128:143]
    ds_read_b64_tr_b16 a[88:89], v9 offset:18432
    ds_read_b64_tr_b16 a[90:91], v9 offset:18944
    ds_read_b64_tr_b16 a[92:93], v10 offset:18432
    ds_read_b64_tr_b16 a[94:95], v10 offset:18944
    v_mfma_f32_32x32x16_bf16 v[144:159], a[148:151], v[104:107], v[144:159]
    buffer_load_dwordx4 v[104:107], v21, s[36:39], s93 offen offset:2048 sc1
    s_waitcnt vmcnt(22)
    v_max3_u32 v20, v112, v113, v114
    v_max_u32 v20, v20, v115
    s_waitcnt vmcnt(21)
    v_max3_u32 v20, v116, v117, v20
    v_max3_u32 v20, v118, v119, v20
    s_waitcnt vmcnt(20)
    v_max3_u32 v20, v120, v121, v20
    v_mfma_f32_32x32x16_bf16 v[128:143], a[152:155], v[108:111], v[128:143]
    v_max3_u32 v20, v122, v123, v20
    s_waitcnt vmcnt(19)
    v_max3_u32 v20, v124, v125, v20
    v_max3_u32 v20, v126, v127, v20
    v_cmp_eq_u32 vcc, -1, v20
    v_mfma_f32_32x32x16_bf16 v[144:159], a[156:159], v[108:111], v[144:159]
    buffer_load_dwordx4 v[108:111], v21, s[36:39], s93 offen offset:3072 sc1
    s_cbranch_vccnz L_slow5
L_back5:
    v_mfma_f32_32x32x16_bf16 v[128:143], a[160:163], v[112:115], v[128:143]
    ds_read_b64_tr_b16 a[96:97], v11 offset:49152
    ds_read_b64_tr_b16 a[98:99], v11 offset:49664
    v_mfma_f32_32x32x16_bf16 v[144:159], a[164:167], v[112:115], v[144:159]
    s_add_u32 s93, s87, 77824
    buffer_load_dwordx4 v[112:115], v21, s[36:39], s93 offen offset:0 sc1
    ds_read_b64_tr_b16 a[100:101], v12 offset:49152
    ds_read_b64_tr_b16 a[102:103], v12 offset:49664
    ds_read_b64_tr_b16 a[104:105], v11 offset:51200
    v_mfma_f32_32x32x16_bf16 v[128:143], a[168:171], v[116:119], v[128:143]
    ds_read_b64_tr_b16 a[106:107], v11 offset:51712
    ds_read_b64_tr_b16 a[108:109], v12 offset:51200
    ds_read_b64_tr_b16 a[110:111], v12 offset:51712
    v_mfma_f32_32x32x16_bf16 v[144:159], a[172:175], v[116:119], v[144:159]
    buffer_load_dwordx4 v[116:119], v21, s[36:39], s93 offen offset:1024 sc1
    ds_read_b64_tr_b16 a[112:113], v13 offset:0
    ds_read_b64_tr_b16 a[114:115], v13 offset:512
    ds_read_b64_tr_b16 a[116:117], v14 offset:0
    ds_read_b64_tr_b16 a[118:119], v14 offset:512
    v_mfma_f32_32x32x16_bf16 v[128:143], a[176:179], v[120:123], v[128:143]
    ds_read_b64_tr_b16 a[120:121], v13 offset:2048
    ds_read_b64_tr_b16 a[122:123], v13 offset:2560
    ds_read_b64_tr_b16 a[124:125], v14 offset:2048
    ds_read_b64_tr_b16 a[126:127], v14 offset:2560
    v_mfma_f32_32x32x16_bf16 v[144:159], a[180:183], v[120:123], v[144:159]
    buffer_load_dwordx4 v[120:123], v21, s[36:39], s93 offen offset:2048 sc1
    s_waitcnt vmcnt(22)
    v_max3_u32 v20, v192, v193, v194
    v_max_u32 v20, v20, v195
    s_waitcnt vmcnt(21)
    v_max3_u32 v20, v196, v197, v20
    v_max3_u32 v20, v198, v199, v20
    s_waitcnt vmcnt(20)
    v_max3_u32 v20, v200, v201, v20
    v_mfma_f32_32x32x16_bf16 v[128:143], a[184:187], v[124:127], v[128:143]
    v_max3_u32 v20, v202, v203, v20
    s_waitcnt vmcnt(19)
    v_max3_u32 v20, v204, v205, v20
    v_max3_u32 v20, v206, v207, v20
    v_cmp_eq_u32 vcc, -1, v20
    v_mfma_f32_32x32x16_bf16 v[144:159], a[188:191], v[124:127], v[144:159]
    buffer_load_dwordx4 v[124:127], v21, s[36:39], s93 offen offset:3072 sc1
    s_cbranch_vccnz L_slow6
L_back6:
    v_mfma_f32_32x32x16_bf16 v[128:143], a[192:195], v[192:195], v[128:143]
    v_mfma_f32_32x32x16_bf16 v[144:159], a[196:199], v[192:195], v[144:159]
    s_add_u32 s93, s87, 57344
    buffer_load_dwordx4 v[192:195], v21, s[36:39], s93 offen offset:0 sc1
    v_mfma_f32_32x32x16_bf16 v[128:143], a[200:203], v[196:199], v[128:143]
    v_mfma_f32_32x32x16_bf16 v[144:159], a[204:207], v[196:199], v[144:159]
    buffer_load_dwordx4 v[196:199], v21, s[36:39], s93 offen offset:1024 sc1
    s_waitcnt vmcnt(21)
    v_max3_u32 v20, v208, v209, v210
    v_max_u32 v20, v20, v211
    s_waitcnt vmcnt(20)
    v_max3_u32 v20, v212, v213, v20
    v_mfma_f32_32x32x16_bf16 v[128:143], a[208:211], v[200:203], v[128:143]
    v_max3_u32 v20, v214, v215, v20
    s_waitcnt vmcnt(19)
    v_max3_u32 v20, v216, v217, v20
    v_mfma_f32_32x32x16_bf16 v[144:159], a[212:215], v[200:203], v[144:159]
    buffer_load_dwordx4 v[200:203], v21, s[36:39], s93 offen offset:2048 sc1
    v_max3_u32 v20, v218, v219, v20
    s_waitcnt vmcnt(19)
    v_max3_u32 v20, v220, v221, v20
    v_mfma_f32_32x32x16_bf16 v[128:143], a[216:219], v[204:207], v[128:143]
    v_max3_u32 v20, v222, v223, v20
    v_cmp_eq_u32 vcc, -1, v20
    v_mfma_f32_32x32x16_bf16 v[144:159], a[220:223], v[204:207], v[144:159]
    buffer_load_dwordx4 v[204:207], v21, s[36:39], s93 offen offset:3072 sc1
    s_cbranch_vccnz L_slow7
L_back7:
    v_mfma_f32_32x32x16_bf16 v[128:143], a[224:227], v[208:211], v[128:143]
    v_mfma_f32_32x32x16_bf16 v[144:159], a[228:231], v[208:211], v[144:159]
    s_add_u32 s93, s87, 61440
    buffer_load_dwordx4 v[208:211], v21, s[36:39], s93 offen offset:0 sc1
    v_mfma_f32_32x32x16_bf16 v[128:143], a[232:235], v[212:215], v[128:143]
    v_mfma_f32_32x32x16_bf16 v[144:159], a[236:239], v[212:215], v[144:159]
    buffer_load_dwordx4 v[212:215], v21, s[36:39], s93 offen offset:1024 sc1
    s_waitcnt vmcnt(21)
    v_max3_u32 v20, v224, v225, v226
    v_max_u32 v20, v20, v227
    s_waitcnt vmcnt(20)
    v_max3_u32 v20, v228, v229, v20
    v_mfma_f32_32x32x16_bf16 v[128:143], a[240:243], v[216:219], v[128:143]
    v_max3_u32 v20, v230, v231, v20
    s_waitcnt vmcnt(19)
    v_max3_u32 v20, v232, v233, v20
    v_mfma_f32_32x32x16_bf16 v[144:159], a[244:247], v[216:219], v[144:159]
    buffer_load_dwordx4 v[216:219], v21, s[36:39], s93 offen offset:2048 sc1
    v_max3_u32 v20, v234, v235, v20
    s_waitcnt vmcnt(19)
    v_max3_u32 v20, v236, v237, v20
    v_mfma_f32_32x32x16_bf16 v[128:143], a[248:251], v[220:223], v[128:143]
    v_max3_u32 v20, v238, v239, v20
    v_cmp_eq_u32 vcc, -1, v20
    v_mfma_f32_32x32x16_bf16 v[144:159], a[252:255], v[220:223], v[144:159]
    buffer_load_dwordx4 v[220:223], v21, s[36:39], s93 offen offset:3072 sc1
    s_cbranch_vccnz L_slow8
L_back8:
    s_waitcnt lgkmcnt(0)
    s_barrier
    v_mfma_f32_32x32x16_bf16 v[64:79], a[0:3], v[224:227], v[64:79]
    v_mfma_f32_32x32x16_bf16 v[80:95], a[4:7], v[224:227], v[80:95]
    s_add_u32 s93, s87, 81920
    buffer_load_dwordx4 v[224:227], v21, s[36:39], s93 offen offset:0 sc1
    v_mfma_f32_32x32x16_bf16 v[64:79], a[8:11], v[228:231], v[64:79]
    v_mfma_f32_32x32x16_bf16 v[80:95], a[12:15], v[228:231], v[80:95]
    buffer_load_dwordx4 v[228:231], v21, s[36:39], s93 offen offset:1024 sc1
    s_waitcnt vmcnt(21)
    v_max3_u32 v20, v240, v241, v242
    v_max_u32 v20, v20, v243
    s_waitcnt vmcnt(20)
    v_max3_u32 v20, v244, v245, v20
    v_mfma_f32_32x32x16_bf16 v[64:79], a[16:19], v[232:235], v[64:79]
    v_max3_u32 v20, v246, v247, v20
    s_waitcnt vmcnt(19)
    v_max3_u32 v20, v248, v249, v20
    v_mfma_f32_32x32x16_bf16 v[80:95], a[20:23], v[232:235], v[80:95]
    buffer_load_dwordx4 v[232:235], v21, s[36:39], s93 offen offset:2048 sc1
    v_max3_u32 v20, v250, v251, v20
    s_waitcnt vmcnt(19)
    v_max3_u32 v20, v252, v253, v20
    v_mfma_f32_32x32x16_bf16 v[64:79], a[24:27], v[236:239], v[64:79]
    v_max3_u32 v20, v254, v255, v20
    v_cmp_eq_u32 vcc, -1, v20
    v_mfma_f32_32x32x16_bf16 v[80:95], a[28:31], v[236:239], v[80:95]
    buffer_load_dwordx4 v[236:239], v21, s[36:39], s93 offen offset:3072 sc1
    s_cbranch_vccnz L_slow9
L_back9:
    v_mfma_f32_32x32x16_bf16 v[64:79], a[32:35], v[240:243], v[64:79]
    v_mfma_f32_32x32x16_bf16 v[80:95], a[36:39], v[240:243], v[80:95]
    s_add_u32 s93, s87, 86016
    buffer_load_dwordx4 v[240:243], v21, s[36:39], s93 offen offset:0 sc1
    v_mfma_f32_32x32x16_bf16 v[64:79], a[40:43], v[244:247], v[64:79]
    v_mfma_f32_32x32x16_bf16 v[80:95], a[44:47], v[244:247], v[80:95]
    buffer_load_dwordx4 v[244:247], v21, s[36:39], s93 offen offset:1024 sc1
    s_waitcnt vmcnt(21)
    v_max3_u32 v20, v96, v97, v98
    v_max_u32 v20, v20, v99
    s_waitcnt vmcnt(20)
    v_max3_u32 v20, v100, v101, v20
    v_mfma_f32_32x32x16_bf16 v[64:79], a[48:51], v[248:251], v[64:79]
    v_max3_u32 v20, v102, v103, v20
    s_waitcnt vmcnt(19)
    v_max3_u32 v20, v104, v105, v20
    v_mfma_f32_32x32x16_bf16 v[80:95], a[52:55], v[248:251], v[80:95]
    buffer_load_dwordx4 v[248:251], v21, s[36:39], s93 offen offset:2048 sc1
    v_max3_u32 v20, v106, v107, v20
    s_waitcnt vmcnt(19)
    v_max3_u32 v20, v108, v109, v20
    v_mfma_f32_32x32x16_bf16 v[64:79], a[56:59], v[252:255], v[64:79]
    v_max3_u32 v20, v110, v111, v20
    v_cmp_eq_u32 vcc, -1, v20
    v_mfma_f32_32x32x16_bf16 v[80:95], a[60:63], v[252:255], v[80:95]
    buffer_load_dwordx4 v[252:255], v21, s[36:39], s93 offen offset:3072 sc1
    s_cbranch_vccnz L_slow10
L_back10:
    v_mfma_f32_32x32x16_bf16 v[64:79], a[64:67], v[96:99], v[64:79]
    v_mfma_f32_32x32x16_bf16 v[80:95], a[68:71], v[96:99], v[80:95]
    s_add_u32 s93, s87, 16384
    buffer_load_dwordx4 v[96:99], v21, s[36:39], s93 offen offset:0 sc1
    v_mfma_f32_32x32x16_bf16 v[64:79], a[72:75], v[100:103], v[64:79]
    v_mfma_f32_32x32x16_bf16 v[80:95], a[76:79], v[100:103], v[80:95]
    buffer_load_dwordx4 v[100:103], v21, s[36:39], s93 offen offset:1024 sc1
    s_waitcnt vmcnt(21)
    v_max3_u32 v20, v112, v113, v114
    v_max_u32 v20, v20, v115
    s_waitcnt vmcnt(20)
    v_max3_u32 v20, v116, v117, v20
    v_mfma_f32_32x32x16_bf16 v[64:79], a[80:83], v[104:107], v[64:79]
    v_max3_u32 v20, v118, v119, v20
    s_waitcnt vmcnt(19)
    v_max3_u32 v20, v120, v121, v20
    v_mfma_f32_32x32x16_bf16 v[80:95], a[84:87], v[104:107], v[80:95]
    buffer_load_dwordx4 v[104:107], v21, s[36:39], s93 offen offset:2048 sc1
    v_max3_u32 v20, v122, v123, v20
    s_waitcnt vmcnt(19)
    v_max3_u32 v20, v124, v125, v20
    v_mfma_f32_32x32x16_bf16 v[64:79], a[88:91], v[108:111], v[64:79]
    v_max3_u32 v20, v126, v127, v20
    v_cmp_eq_u32 vcc, -1, v20
    v_mfma_f32_32x32x16_bf16 v[80:95], a[92:95], v[108:111], v[80:95]
    buffer_load_dwordx4 v[108:111], v21, s[36:39], s93 offen offset:3072 sc1
    s_cbranch_vccnz L_slow11
L_back11:
    v_mfma_f32_32x32x16_bf16 v[64:79], a[96:99], v[112:115], v[64:79]
    v_mfma_f32_32x32x16_bf16 v[80:95], a[100:103], v[112:115], v[80:95]
    s_add_u32 s93, s87, 20480
    buffer_load_dwordx4 v[112:115], v21, s[36:39], s93 offen offset:0 sc1
    v_mfma_f32_32x32x16_bf16 v[64:79], a[104:107], v[116:119], v[64:79]
    v_mfma_f32_32x32x16_bf16 v[80:95], a[108:111], v[116:119], v[80:95]
    buffer_load_dwordx4 v[116:119], v21, s[36:39], s93 offen offset:1024 sc1
    s_waitcnt vmcnt(21)
    v_max3_u32 v20, v192, v193, v194
    v_max_u32 v20, v20, v195
    s_waitcnt vmcnt(20)
    v_max3_u32 v20, v196, v197, v20
    v_mfma_f32_32x32x16_bf16 v[64:79], a[112:115], v[120:123], v[64:79]
    v_max3_u32 v20, v198, v199, v20
    s_waitcnt vmcnt(19)
    v_max3_u32 v20, v200, v201, v20
    v_mfma_f32_32x32x16_bf16 v[80:95], a[116:119], v[120:123], v[80:95]
    buffer_load_dwordx4 v[120:123], v21, s[36:39], s93 offen offset:2048 sc1
    v_max3_u32 v20, v202, v203, v20
    s_waitcnt vmcnt(19)
    v_max3_u32 v20, v204, v205, v20
    v_mfma_f32_32x32x16_bf16 v[64:79], a[120:123], v[124:127], v[64:79]
    v_max3_u32 v20, v206, v207, v20
    v_cmp_eq_u32 vcc, -1, v20
    v_mfma_f32_32x32x16_bf16 v[80:95], a[124:127], v[124:127], v[80:95]
    buffer_load_dwordx4 v[124:127], v21, s[36:39], s93 offen offset:3072 sc1
    s_cbranch_vccnz L_slow12
L_back12:
    v_mfma_f32_32x32x16_bf16 v[128:143], a[0:3], v[192:195], v[128:143]
    s_nop 5
    ds_write_b128 v28, v[64:67] offset:0
    ds_write_b128 v28, v[68:71] offset:8192
    v_mfma_f32_32x32x16_bf16 v[144:159], a[4:7], v[192:195], v[144:159]
    s_add_u32 s93, s87, 40960
    buffer_load_dwordx4 v[192:195], v21, s[36:39], s93 offen offset:0 sc1
    ds_write_b128 v28, v[72:75] offset:16384
    v_mfma_f32_32x32x16_bf16 v[128:143], a[8:11], v[196:199], v[128:143]
    ds_write_b128 v28, v[76:79] offset:24576
    v_mfma_f32_32x32x16_bf16 v[144:159], a[12:15], v[196:199], v[144:159]
    buffer_load_dwordx4 v[196:199], v21, s[36:39], s93 offen offset:1024 sc1
    ds_write_b128 v28, v[80:83] offset:1024
    ds_write_b128 v28, v[84:87] offset:9216
    ds_write_b128 v28, v[88:91] offset:17408
    ds_write_b128 v28, v[92:95] offset:25600
    v_mfma_f32_32x32x16_bf16 v[128:143], a[16:19], v[200:203], v[128:143]
    s_waitcnt vmcnt(21)
    v_max3_u32 v20, v208, v209, v210
    v_max_u32 v20, v20, v211
    s_waitcnt vmcnt(20)
    v_max3_u32 v20, v212, v213, v20
    v_mfma_f32_32x32x16_bf16 v[144:159], a[20:23], v[200:203], v[144:159]
    buffer_load_dwordx4 v[200:203], v21, s[36:39], s93 offen offset:2048 sc1
    v_max3_u32 v20, v214, v215, v20
    s_waitcnt vmcnt(20)
    v_max3_u32 v20, v216, v217, v20
    v_max3_u32 v20, v218, v219, v20
    v_mfma_f32_32x32x16_bf16 v[128:143], a[24:27], v[204:207], v[128:143]
    s_waitcnt vmcnt(19)
    v_max3_u32 v20, v220, v221, v20
    v_max3_u32 v20, v222, v223, v20
    v_cmp_eq_u32 vcc, -1, v20
    v_mfma_f32_32x32x16_bf16 v[144:159], a[28:31], v[204:207], v[144:159]
    buffer_load_dwordx4 v[204:207], v21, s[36:39], s93 offen offset:3072 sc1
    s_cbranch_vccnz L_slow13
L_back13:
    v_mfma_f32_32x32x16_bf16 v[128:143], a[32:35], v[208:211], v[128:143]
    v_mfma_f32_32x32x16_bf16 v[144:159], a[36:39], v[208:211], v[144:159]
    s_add_u32 s93, s87, 45056
    buffer_load_dwordx4 v[208:211], v21, s[36:39], s93 offen offset:0 sc1
    v_mfma_f32_32x32x16_bf16 v[128:143], a[40:43], v[212:215], v[128:143]
    v_mfma_f32_32x32x16_bf16 v[144:159], a[44:47], v[212:215], v[144:159]
    buffer_load_dwordx4 v[212:215], v21, s[36:39], s93 offen offset:1024 sc1
    s_waitcnt vmcnt(21)
    v_max3_u32 v20, v224, v225, v226
    v_max_u32 v20, v20, v227
    s_waitcnt vmcnt(20)
    v_max3_u32 v20, v228, v229, v20
    v_mfma_f32_32x32x16_bf16 v[128:143], a[48:51], v[216:219], v[128:143]
    v_max3_u32 v20, v230, v231, v20
    s_waitcnt vmcnt(19)
    v_max3_u32 v20, v232, v233, v20
    v_mfma_f32_32x32x16_bf16 v[144:159], a[52:55], v[216:219], v[144:159]
    buffer_load_dwordx4 v[216:219], v21, s[36:39], s93 offen offset:2048 sc1
    v_max3_u32 v20, v234, v235, v20
    s_waitcnt vmcnt(19)
    v_max3_u32 v20, v236, v237, v20
    v_mfma_f32_32x32x16_bf16 v[128:143], a[56:59], v[220:223], v[128:143]
    v_max3_u32 v20, v238, v239, v20
    v_cmp_eq_u32 vcc, -1, v20
    v_mfma_f32_32x32x16_bf16 v[144:159], a[60:63], v[220:223], v[144:159]
    buffer_load_dwordx4 v[220:223], v21, s[36:39], s93 offen offset:3072 sc1
    s_cbranch_vccnz L_slow14
L_back14:
    s_waitcnt lgkmcnt(0)
    s_barrier
    v_mfma_f32_32x32x16_bf16 v[128:143], a[64:67], v[224:227], v[128:143]
    ds_read_b128 v[64:67], v17 offset:0
    ds_read_b128 v[68:71], v17 offset:2048
    v_mfma_f32_32x32x16_bf16 v[144:159], a[68:71], v[224:227], v[144:159]
    s_add_u32 s93, s87, 65536
    buffer_load_dwordx4 v[224:227], v21, s[36:39], s93 offen offset:0 sc1
    ds_read_b128 v[72:75], v17 offset:4096
    v_mfma_f32_32x32x16_bf16 v[128:143], a[72:75], v[228:231], v[128:143]
    ds_read_b128 v[76:79], v17 offset:6144
    v_mfma_f32_32x32x16_bf16 v[144:159], a[76:79], v[228:231], v[144:159]
    buffer_load_dwordx4 v[228:231], v21, s[36:39], s93 offen offset:1024 sc1
    ds_read_b128 v[80:83], v16 offset:0
    ds_read_b128 v[84:87], v16 offset:2048
    ds_read_b128 v[88:91], v16 offset:4096
    ds_read_b128 v[92:95], v16 offset:6144
    v_mfma_f32_32x32x16_bf16 v[128:143], a[80:83], v[232:235], v[128:143]
    s_waitcnt vmcnt(21)
    v_max3_u32 v20, v240, v241, v242
    v_max_u32 v20, v20, v243
    s_waitcnt vmcnt(20)
    v_max3_u32 v20, v244, v245, v20
    v_mfma_f32_32x32x16_bf16 v[144:159], a[84:87], v[232:235], v[144:159]
    buffer_load_dwordx4 v[232:235], v21, s[36:39], s93 offen offset:2048 sc1
    v_max3_u32 v20, v246, v247, v20
    s_waitcnt vmcnt(20)
    v_max3_u32 v20, v248, v249, v20
    v_max3_u32 v20, v250, v251, v20
    v_mfma_f32_32x32x16_bf16 v[128:143], a[88:91], v[236:239], v[128:143]
    s_waitcnt vmcnt(19)
    v_max3_u32 v20, v252, v253, v20
    v_max3_u32 v20, v254, v255, v20
    v_cmp_eq_u32 vcc, -1, v20
    v_mfma_f32_32x32x16_bf16 v[144:159], a[92:95], v[236:239], v[144:159]
    buffer_load_dwordx4 v[236:239], v21, s[36:39], s93 offen offset:3072 sc1
    s_cbranch_vccnz L_slow15
L_back15:
    v_mfma_f32_32x32x16_bf16 v[128:143], a[96:99], v[240:243], v[128:143]
    s_waitcnt lgkmcnt(6)
    v_add_f32 v64, v64, v68
    s_waitcnt lgkmcnt(4)
    v_add_f32 v72, v72, v76
    v_add_f32 v65, v65, v69
    v_add_f32 v73, v73, v77
    v_mfma_f32_32x32x16_bf16 v[144:159], a[100:103], v[240:243], v[144:159]
    s_add_u32 s93, s87, 69632
    buffer_load_dwordx4 v[240:243], v21, s[36:39], s93 offen offset:0 sc1
    v_add_f32 v66, v66, v70
    v_add_f32 v74, v74, v78
    v_add_f32 v67, v67, v71
    v_add_f32 v75, v75, v79
    v_mfma_f32_32x32x16_bf16 v[128:143], a[104:107], v[244:247], v[128:143]
    v_add_f32 v64, v64, v72
    v_add_f32 v65, v65, v73
    v_add_f32 v66, v66, v74
    v_add_f32 v67, v67, v75
    v_mfma_f32_32x32x16_bf16 v[144:159], a[108:111], v[244:247], v[144:159]
    buffer_load_dwordx4 v[244:247], v21, s[36:39], s93 offen offset:1024 sc1
    buffer_store_dwordx4 v[64:67], v21, s[36:39], s88 offen sc1
    s_waitcnt lgkmcnt(2)
    v_add_f32 v80, v80, v84
    s_waitcnt lgkmcnt(0)
    v_add_f32 v88, v88, v92
    v_add_f32 v81, v81, v85
    v_add_f32 v89, v89, v93
    v_add_f32 v82, v82, v86
    v_mfma_f32_32x32x16_bf16 v[128:143], a[112:115], v[248:251], v[128:143]
    v_add_f32 v90, v90, v94
    v_add_f32 v83, v83, v87
    v_add_f32 v91, v91, v95
    v_add_f32 v80, v80, v88
    v_add_f32 v81, v81, v89
    v_mfma_f32_32x32x16_bf16 v[144:159], a[116:119], v[248:251], v[144:159]
    buffer_load_dwordx4 v[248:251], v21, s[36:39], s93 offen offset:2048 sc1
    v_add_f32 v82, v82, v90
    v_add_f32 v83, v83, v91
    s_waitcnt vmcnt(23)
    v_max3_u32 v20, v96, v97, v98
    v_max_u32 v20, v20, v99
    s_waitcnt vmcnt(22)
    v_max3_u32 v20, v100, v101, v20
    v_max3_u32 v20, v102, v103, v20
    v_mfma_f32_32x32x16_bf16 v[128:143], a[120:123], v[252:255], v[128:143]
    s_waitcnt vmcnt(21)
    v_max3_u32 v20, v104, v105, v20
    v_max3_u32 v20, v106, v107, v20
    s_waitcnt vmcnt(20)
    v_max3_u32 v20, v108, v109, v20
    v_max3_u32 v20, v110, v111, v20
    v_cmp_eq_u32 vcc, -1, v20
    v_mfma_f32_32x32x16_bf16 v[144:159], a[124:127], v[252:255], v[144:159]
    buffer_load_dwordx4 v[252:255], v21, s[36:39], s93 offen offset:3072 sc1
    s_cbranch_vccnz L_slow16
L_back16:
    v_mfma_f32_32x32x16_bf16 v[160:175], a[128:131], v[96:99], 0
    s_nop 0
    ds_write_b128 v28, v[128:131] offset:32768
    ds_write_b128 v28, v[132:135] offset:40960
    v_mfma_f32_32x32x16_bf16 v[176:191], a[132:135], v[96:99], 0
    s_add_u32 s93, s87, 90112
    buffer_load_dwordx4 v[96:99], v21, s[36:39], s93 offen offset:0 sc1
    ds_write_b128 v28, v[136:139] offset:49152
    v_mfma_f32_32x32x16_bf16 v[160:175], a[136:139], v[100:103], v[160:175]
    ds_write_b128 v28, v[140:143] offset:57344
    v_mfma_f32_32x32x16_bf16 v[176:191], a[140:143], v[100:103], v[176:191]
    buffer_load_dwordx4 v[100:103], v21, s[36:39], s93 offen offset:1024 sc1
    ds_write_b128 v28, v[144:147] offset:33792
    ds_write_b128 v28, v[148:151] offset:41984
    ds_write_b128 v28, v[152:155] offset:50176
    ds_write_b128 v28, v[156:159] offset:58368
    v_mfma_f32_32x32x16_bf16 v[160:175], a[144:147], v[104:107], v[160:175]
    s_waitcnt vmcnt(22)
    v_max3_u32 v20, v112, v113, v114
    v_max_u32 v20, v20, v115
    s_waitcnt vmcnt(21)
    v_max3_u32 v20, v116, v117, v20
    v_mfma_f32_32x32x16_bf16 v[176:191], a[148:151], v[104:107], v[176:191]
    buffer_load_dwordx4 v[104:107], v21, s[36:39], s93 offen offset:2048 sc1
    v_max3_u32 v20, v118, v119, v20
    s_waitcnt vmcnt(21)
    v_max3_u32 v20, v120, v121, v20
    v_max3_u32 v20, v122, v123, v20
    v_mfma_f32_32x32x16_bf16 v[160:175], a[152:155], v[108:111], v[160:175]
    s_waitcnt vmcnt(20)
    v_max3_u32 v20, v124, v125, v20
    v_max3_u32 v20, v126, v127, v20
    v_cmp_eq_u32 vcc, -1, v20
    v_mfma_f32_32x32x16_bf16 v[176:191], a[156:159], v[108:111], v[176:191]
    buffer_load_dwordx4 v[108:111], v21, s[36:39], s93 offen offset:3072 sc1
    s_cbranch_vccnz L_slow17
L_back17:
    v_mfma_f32_32x32x16_bf16 v[160:175], a[160:163], v[112:115], v[160:175]
    v_mfma_f32_32x32x16_bf16 v[176:191], a[164:167], v[112:115], v[176:191]
    s_add_u32 s93, s87, 94208
    buffer_load_dwordx4 v[112:115], v21, s[36:39], s93 offen offset:0 sc1
    v_mfma_f32_32x32x16_bf16 v[160:175], a[168:171], v[116:119], v[160:175]
    v_mfma_f32_32x32x16_bf16 v[176:191], a[172:175], v[116:119], v[176:191]
    buffer_load_dwordx4 v[116:119], v21, s[36:39], s93 offen offset:1024 sc1
    s_waitcnt vmcnt(22)
    v_max3_u32 v20, v192, v193, v194
    v_max_u32 v20, v20, v195
    s_waitcnt vmcnt(21)
    v_max3_u32 v20, v196, v197, v20
    v_mfma_f32_32x32x16_bf16 v[160:175], a[176:179], v[120:123], v[160:175]
    v_max3_u32 v20, v198, v199, v20
    s_waitcnt vmcnt(20)
    v_max3_u32 v20, v200, v201, v20
    v_mfma_f32_32x32x16_bf16 v[176:191], a[180:183], v[120:123], v[176:191]
    buffer_load_dwordx4 v[120:123], v21, s[36:39], s93 offen offset:2048 sc1
    v_max3_u32 v20, v202, v203, v20
    s_waitcnt vmcnt(20)
    v_max3_u32 v20, v204, v205, v20
    v_mfma_f32_32x32x16_bf16 v[160:175], a[184:187], v[124:127], v[160:175]
    v_max3_u32 v20, v206, v207, v20
    v_cmp_eq_u32 vcc, -1, v20
    v_mfma_f32_32x32x16_bf16 v[176:191], a[188:191], v[124:127], v[176:191]
    buffer_load_dwordx4 v[124:127], v21, s[36:39], s93 offen offset:3072 sc1
    s_cbranch_vccnz L_slow18
L_back18:
    s_waitcnt lgkmcnt(0)
    s_barrier
    v_mfma_f32_32x32x16_bf16 v[160:175], a[192:195], v[192:195], v[160:175]
    ds_read_b128 v[128:131], v17 offset:32768
    ds_read_b128 v[132:135], v17 offset:34816
    v_mfma_f32_32x32x16_bf16 v[176:191], a[196:199], v[192:195], v[176:191]
    ds_read_b128 v[136:139], v17 offset:36864
    v_mfma_f32_32x32x16_bf16 v[160:175], a[200:203], v[196:199], v[160:175]
    ds_read_b128 v[140:143], v17 offset:38912
    v_mfma_f32_32x32x16_bf16 v[176:191], a[204:207], v[196:199], v[176:191]
    ds_read_b128 v[144:147], v16 offset:32768
    ds_read_b128 v[148:151], v16 offset:34816
    ds_read_b128 v[152:155], v16 offset:36864
    ds_read_b128 v[156:159], v16 offset:38912
    v_mfma_f32_32x32x16_bf16 v[160:175], a[208:211], v[200:203], v[160:175]
    s_waitcnt vmcnt(20)
    v_max3_u32 v20, v208, v209, v210
    v_max_u32 v20, v20, v211
    s_waitcnt vmcnt(19)
    v_max3_u32 v20, v212, v213, v20
    v_mfma_f32_32x32x16_bf16 v[176:191], a[212:215], v[200:203], v[176:191]
    v_max3_u32 v20, v214, v215, v20
    s_waitcnt vmcnt(18)
    v_max3_u32 v20, v216, v217, v20
    v_max3_u32 v20, v218, v219, v20
    v_mfma_f32_32x32x16_bf16 v[160:175], a[216:219], v[204:207], v[160:175]
    s_waitcnt vmcnt(17)
    v_max3_u32 v20, v220, v221, v20
    v_max3_u32 v20, v222, v223, v20
    v_cmp_eq_u32 vcc, -1, v20
    v_mfma_f32_32x32x16_bf16 v[176:191], a[220:223], v[204:207], v[176:191]
    s_cbranch_vccnz L_slow19
L_back19:
    v_mfma_f32_32x32x16_bf16 v[160:175], a[224:227], v[208:211], v[160:175]
    s_waitcnt lgkmcnt(6)
    v_add_f32 v128, v128, v132
    s_waitcnt lgkmcnt(4)
    v_add_f32 v136, v136, v140
    v_add_f32 v129, v129, v133
    v_add_f32 v137, v137, v141
    v_mfma_f32_32x32x16_bf16 v[176:191], a[228:231], v[208:211], v[176:191]
    v_add_f32 v130, v130, v134
    v_add_f32 v138, v138, v142
    v_add_f32 v131, v131, v135
    v_add_f32 v139, v139, v143
    v_mfma_f32_32x32x16_bf16 v[160:175], a[232:235], v[212:215], v[160:175]
    v_add_f32 v128, v128, v136
    v_add_f32 v129, v129, v137
    v_add_f32 v130, v130, v138
    v_add_f32 v131, v131, v139
    v_mfma_f32_32x32x16_bf16 v[176:191], a[236:239], v[212:215], v[176:191]
    buffer_store_dwordx4 v[128:131], v21, s[36:39], s95 offen sc1
    s_waitcnt lgkmcnt(2)
    v_add_f32 v144, v144, v148
    s_waitcnt lgkmcnt(0)
    v_add_f32 v152, v152, v156
    v_add_f32 v145, v145, v149
    v_add_f32 v153, v153, v157
    v_add_f32 v146, v146, v150
    v_mfma_f32_32x32x16_bf16 v[160:175], a[240:243], v[216:219], v[160:175]
    v_add_f32 v154, v154, v158
    v_add_f32 v147, v147, v151
    v_add_f32 v155, v155, v159
    v_add_f32 v144, v144, v152
    v_add_f32 v145, v145, v153
    v_mfma_f32_32x32x16_bf16 v[176:191], a[244:247], v[216:219], v[176:191]
    v_add_f32 v146, v146, v154
    v_add_f32 v147, v147, v155
    s_waitcnt vmcnt(17)
    v_max3_u32 v20, v224, v225, v226
    v_max_u32 v20, v20, v227
    s_waitcnt vmcnt(16)
    v_max3_u32 v20, v228, v229, v20
    v_max3_u32 v20, v230, v231, v20
    v_mfma_f32_32x32x16_bf16 v[160:175], a[248:251], v[220:223], v[160:175]
    s_waitcnt vmcnt(15)
    v_max3_u32 v20, v232, v233, v20
    v_max3_u32 v20, v234, v235, v20
    s_waitcnt vmcnt(14)
    v_max3_u32 v20, v236, v237, v20
    v_max3_u32 v20, v238, v239, v20
    v_cmp_eq_u32 vcc, -1, v20
    v_mfma_f32_32x32x16_bf16 v[176:191], a[252:255], v[220:223], v[176:191]
    s_cbranch_vccnz L_slow20
L_back20:
    v_mfma_f32_32x32x16_bf16 v[160:175], a[0:3], v[224:227], v[160:175]
    v_mfma_f32_32x32x16_bf16 v[176:191], a[4:7], v[224:227], v[176:191]
    v_mfma_f32_32x32x16_bf16 v[160:175], a[8:11], v[228:231], v[160:175]
    v_mfma_f32_32x32x16_bf16 v[176:191], a[12:15], v[228:231], v[176:191]
    s_waitcnt vmcnt(13)
    v_max3_u32 v20, v240, v241, v242
    v_max_u32 v20, v20, v243
    s_waitcnt vmcnt(12)
    v_max3_u32 v20, v244, v245, v20
    v_mfma_f32_32x32x16_bf16 v[160:175], a[16:19], v[232:235], v[160:175]
    v_max3_u32 v20, v246, v247, v20
    s_waitcnt vmcnt(10)
    v_max3_u32 v20, v248, v249, v20
    v_mfma_f32_32x32x16_bf16 v[176:191], a[20:23], v[232:235], v[176:191]
    v_max3_u32 v20, v250, v251, v20
    s_waitcnt vmcnt(9)
    v_max3_u32 v20, v252, v253, v20
    v_mfma_f32_32x32x16_bf16 v[160:175], a[24:27], v[236:239], v[160:175]
    v_max3_u32 v20, v254, v255, v20
    v_cmp_eq_u32 vcc, -1, v20
    v_mfma_f32_32x32x16_bf16 v[176:191], a[28:31], v[236:239], v[176:191]
    s_cbranch_vccnz L_slow21
L_back21:
    v_mfma_f32_32x32x16_bf16 v[160:175], a[32:35], v[240:243], v[160:175]
    v_mfma_f32_32x32x16_bf16 v[176:191], a[36:39], v[240:243], v[176:191]
    v_mfma_f32_32x32x16_bf16 v[160:175], a[40:43], v[244:247], v[160:175]
    v_mfma_f32_32x32x16_bf16 v[176:191], a[44:47], v[244:247], v[176:191]
    s_waitcnt vmcnt(8)
    v_max3_u32 v20, v96, v97, v98
    v_max_u32 v20, v20, v99
    s_waitcnt vmcnt(7)
    v_max3_u32 v20, v100, v101, v20
    v_mfma_f32_32x32x16_bf16 v[160:175], a[48:51], v[248:251], v[160:175]
    v_max3_u32 v20, v102, v103, v20
    s_waitcnt vmcnt(6)
    v_max3_u32 v20, v104, v105, v20
    v_mfma_f32_32x32x16_bf16 v[176:191], a[52:55], v[248:251], v[176:191]
    v_max3_u32 v20, v106, v107, v20
    s_waitcnt vmcnt(5)
    v_max3_u32 v20, v108, v109, v20
    v_mfma_f32_32x32x16_bf16 v[160:175], a[56:59], v[252:255], v[160:175]
    v_max3_u32 v20, v110, v111, v20
    v_cmp_eq_u32 vcc, -1, v20
    v_mfma_f32_32x32x16_bf16 v[176:191], a[60:63], v[252:255], v[176:191]
    s_cbranch_vccnz L_slow22
L_back22:
    v_mfma_f32_32x32x16_bf16 v[160:175], a[64:67], v[96:99], v[160:175]
    v_mfma_f32_32x32x16_bf16 v[176:191], a[68:71], v[96:99], v[176:191]
    v_mfma_f32_32x32x16_bf16 v[160:175], a[72:75], v[100:103], v[160:175]
    v_mfma_f32_32x32x16_bf16 v[176:191], a[76:79], v[100:103], v[176:191]
    s_waitcnt vmcnt(4)
    v_max3_u32 v20, v112, v113, v114
    v_max_u32 v20, v20, v115
    s_waitcnt vmcnt(3)
    v_max3_u32 v20, v116, v117, v20
    v_mfma_f32_32x32x16_bf16 v[160:175], a[80:83], v[104:107], v[160:175]
    v_max3_u32 v20, v118, v119, v20
    s_waitcnt vmcnt(2)
    v_max3_u32 v20, v120, v121, v20
    v_mfma_f32_32x32x16_bf16 v[176:191], a[84:87], v[104:107], v[176:191]
    v_max3_u32 v20, v122, v123, v20
    s_waitcnt vmcnt(1)
    v_max3_u32 v20, v124, v125, v20
    v_mfma_f32_32x32x16_bf16 v[160:175], a[88:91], v[108:111], v[160:175]
    v_max3_u32 v20, v126, v127, v20
    v_cmp_eq_u32 vcc, -1, v20
    v_mfma_f32_32x32x16_bf16 v[176:191], a[92:95], v[108:111], v[176:191]
    s_cbranch_vccnz L_slow23
L_back23:
    v_mfma_f32_32x32x16_bf16 v[160:175], a[96:99], v[112:115], v[160:175]
    v_mfma_f32_32x32x16_bf16 v[176:191], a[100:103], v[112:115], v[176:191]
    v_mfma_f32_32x32x16_bf16 v[160:175], a[104:107], v[116:119], v[160:175]
    v_mfma_f32_32x32x16_bf16 v[176:191], a[108:111], v[116:119], v[176:191]
    v_mfma_f32_32x32x16_bf16 v[160:175], a[112:115], v[120:123], v[160:175]
    v_mfma_f32_32x32x16_bf16 v[176:191], a[116:119], v[120:123], v[176:191]
    v_mfma_f32_32x32x16_bf16 v[160:175], a[120:123], v[124:127], v[160:175]
    v_mfma_f32_32x32x16_bf16 v[176:191], a[124:127], v[124:127], v[176:191]
    s_nop 10
    ds_write_b128 v28, v[160:163] offset:0
    ds_write_b128 v28, v[164:167] offset:8192
    ds_write_b128 v28, v[168:171] offset:16384
    ds_write_b128 v28, v[172:175] offset:24576
    ds_write_b128 v28, v[176:179] offset:1024
    ds_write_b128 v28, v[180:183] offset:9216
    ds_write_b128 v28, v[184:187] offset:17408
    ds_write_b128 v28, v[188:191] offset:25600
    s_waitcnt lgkmcnt(0)
    s_barrier
    ds_read_b128 v[160:163], v17 offset:0
    ds_read_b128 v[164:167], v17 offset:2048
    ds_read_b128 v[168:171], v17 offset:4096
    ds_read_b128 v[172:175], v17 offset:6144
    ds_read_b128 v[176:179], v16 offset:0
    ds_read_b128 v[180:183], v16 offset:2048
    ds_read_b128 v[184:187], v16 offset:4096
    ds_read_b128 v[188:191], v16 offset:6144
    s_waitcnt lgkmcnt(6)
    v_add_f32 v160, v160, v164
    s_waitcnt lgkmcnt(4)
    v_add_f32 v168, v168, v172
    v_add_f32 v161, v161, v165
    v_add_f32 v169, v169, v173
    v_add_f32 v162, v162, v166
    v_add_f32 v170, v170, v174
    v_add_f32 v163, v163, v167
    v_add_f32 v171, v171, v175
    v_add_f32 v160, v160, v168
    v_add_f32 v161, v161, v169
    v_add_f32 v162, v162, v170
    v_add_f32 v163, v163, v171
    buffer_store_dwordx4 v[160:163], v21, s[36:39], s96 offen sc1
    s_waitcnt lgkmcnt(2)
    v_add_f32 v176, v176, v180
    s_waitcnt lgkmcnt(0)
    v_add_f32 v184, v184, v188
    v_add_f32 v177, v177, v181
    v_add_f32 v185, v185, v189
    v_add_f32 v178, v178, v182
    v_add_f32 v186, v186, v190
    v_add_f32 v179, v179, v183
    v_add_f32 v187, v187, v191
    v_add_f32 v176, v176, v184
    v_add_f32 v177, v177, v185
    v_add_f32 v178, v178, v186
    v_add_f32 v179, v179, v187
    s_movk_i32 s92, 20000
L_mb:
    buffer_load_dwordx4 v[96:99], v21, s[36:39], s80 offen sc1
    buffer_load_dwordx4 v[100:103], v21, s[36:39], s97 offen sc1
    buffer_load_dwordx4 v[104:107], v21, s[36:39], s98 offen sc1
    s_waitcnt vmcnt(0)
    v_max_u32 v108, v96, v97
    v_max3_u32 v108, v98, v99, v108
    v_max3_u32 v108, v100, v101, v108
    v_max3_u32 v108, v102, v103, v108
    v_max3_u32 v108, v104, v105, v108
    v_max3_u32 v108, v106, v107, v108
    v_cmp_eq_u32 vcc, -1, v108
    s_cbranch_vccz L_mb_ok
    s_sleep 1
    s_sub_u32 s92, s92, 1
    s_cmp_lg_u32 s92, 0
    s_cbranch_scc1 L_mb
L_mb_ok:
    s_add_u32 s93, s89, 65536
    s_add_u32 s94, s89, 131072
    v_pk_add_f32 v[80:81], v[80:81], v[96:97]
    v_pk_add_f32 v[82:83], v[82:83], v[98:99]
    v_cvt_pk_bf16_f32 v112, v80, v81
    v_cvt_pk_bf16_f32 v113, v82, v83
    buffer_store_dwordx2 v[112:113], v60, s[72:75], s89 offen
    v_pk_add_f32 v[144:145], v[144:145], v[100:101]
    v_pk_add_f32 v[146:147], v[146:147], v[102:103]
    v_cvt_pk_bf16_f32 v114, v144, v145
    v_cvt_pk_bf16_f32 v115, v146, v147
    buffer_store_dwordx2 v[114:115], v60, s[72:75], s93 offen
    v_pk_add_f32 v[176:177], v[176:177], v[104:105]
    v_pk_add_f32 v[178:179], v[178:179], v[106:107]
    v_cvt_pk_bf16_f32 v116, v176, v177
    v_cvt_pk_bf16_f32 v117, v178, v179
    buffer_store_dwordx2 v[116:117], v60, s[72:75], s94 offen
L_end:
    s_endpgm
L_slow0:
    s_movk_i32 s92, 20000
L_sl0:
    s_add_u32 s94, s87, 0
    buffer_load_dwordx4 v[192:195], v21, s[36:39], s94 offen offset:0 sc1
    buffer_load_dwordx4 v[196:199], v21, s[36:39], s94 offen offset:1024 sc1
    buffer_load_dwordx4 v[200:203], v21, s[36:39], s94 offen offset:2048 sc1
    buffer_load_dwordx4 v[204:207], v21, s[36:39], s94 offen offset:3072 sc1
    s_waitcnt vmcnt(0)
    v_max3_u32 v20, v192, v193, v194
    v_max_u32 v20, v20, v195
    v_max3_u32 v20, v196, v197, v20
    v_max3_u32 v20, v198, v199, v20
    v_max3_u32 v20, v200, v201, v20
    v_max3_u32 v20, v202, v203, v20
    v_max3_u32 v20, v204, v205, v20
    v_max3_u32 v20, v206, v207, v20
    v_cmp_eq_u32 vcc, -1, v20
    s_cbranch_vccz L_back0
L_sd0:
    s_sub_u32 s92, s92, 1
    s_cmp_eq_u32 s92, 0
    s_cbranch_scc1 L_back0
    s_sleep 2
    s_mov_b64 exec, 15
    v_lshlrev_b32 v192, 6, v21
    buffer_load_dword v193, v192, s[36:39], s94 offen offset:1020 sc1
    s_waitcnt vmcnt(0)
    v_cmp_eq_u32 vcc, -1, v193
    s_mov_b64 exec, -1
    s_cbranch_vccnz L_sd0
    s_branch L_sl0
L_slow1:
    s_movk_i32 s92, 20000
L_sl1:
    s_add_u32 s94, s87, 4096
    buffer_load_dwordx4 v[208:211], v21, s[36:39], s94 offen offset:0 sc1
    buffer_load_dwordx4 v[212:215], v21, s[36:39], s94 offen offset:1024 sc1
    buffer_load_dwordx4 v[216:219], v21, s[36:39], s94 offen offset:2048 sc1
    buffer_load_dwordx4 v[220:223], v21, s[36:39], s94 offen offset:3072 sc1
    s_waitcnt vmcnt(0)
    v_max3_u32 v20, v208, v209, v210
    v_max_u32 v20, v20, v211
    v_max3_u32 v20, v212, v213, v20
    v_max3_u32 v20, v214, v215, v20
    v_max3_u32 v20, v216, v217, v20
    v_max3_u32 v20, v218, v219, v20
    v_max3_u32 v20, v220, v221, v20
    v_max3_u32 v20, v222, v223, v20
    v_cmp_eq_u32 vcc, -1, v20
    s_cbranch_vccz L_back1
L_sd1:
    s_sub_u32 s92, s92, 1
    s_cmp_eq_u32 s92, 0
    s_cbranch_scc1 L_back1
    s_sleep 2
    s_mov_b64 exec, 15
    v_lshlrev_b32 v208, 6, v21
    buffer_load_dword v209, v208, s[36:39], s94 offen offset:1020 sc1
    s_waitcnt vmcnt(0)
    v_cmp_eq_u32 vcc, -1, v209
    s_mov_b64 exec, -1
    s_cbranch_vccnz L_sd1
    s_branch L_sl1
L_slow2:
    s_movk_i32 s92, 20000
L_sl2:
    s_add_u32 s94, s87, 24576
    buffer_load_dwordx4 v[224:227], v21, s[36:39], s94 offen offset:0 sc1
    buffer_load_dwordx4 v[228:231], v21, s[36:39], s94 offen offset:1024 sc1
    buffer_load_dwordx4 v[232:235], v21, s[36:39], s94 offen offset:2048 sc1
    buffer_load_dwordx4 v[236:239], v21, s[36:39], s94 offen offset:3072 sc1
    s_waitcnt vmcnt(0)
    v_max3_u32 v20, v224, v225, v226
    v_max_u32 v20, v20, v227
    v_max3_u32 v20, v228, v229, v20
    v_max3_u32 v20, v230, v231, v20
    v_max3_u32 v20, v232, v233, v20
    v_max3_u32 v20, v234, v235, v20
    v_max3_u32 v20, v236, v237, v20
    v_max3_u32 v20, v238, v239, v20
    v_cmp_eq_u32 vcc, -1, v20
    s_cbranch_vccz L_back2
L_sd2:
    s_sub_u32 s92, s92, 1
    s_cmp_eq_u32 s92, 0
    s_cbranch_scc1 L_back2
    s_sleep 2
    s_mov_b64 exec, 15
    v_lshlrev_b32 v224, 6, v21
    buffer_load_dword v225, v224, s[36:39], s94 offen offset:1020 sc1
    s_waitcnt vmcnt(0)
    v_cmp_eq_u32 vcc, -1, v225
    s_mov_b64 exec, -1
    s_cbranch_vccnz L_sd2
    s_branch L_sl2
L_slow3:
    s_movk_i32 s92, 20000
L_sl3:
    s_add_u32 s94, s87, 28672
    buffer_load_dwordx4 v[240:243], v21, s[36:39], s94 offen offset:0 sc1
    buffer_load_dwordx4 v[244:247], v21, s[36:39], s94 offen offset:1024 sc1
    buffer_load_dwordx4 v[248:251], v21, s[36:39], s94 offen offset:2048 sc1
    buffer_load_dwordx4 v[252:255], v21, s[36:39], s94 offen offset:3072 sc1
    s_waitcnt vmcnt(0)
    v_max3_u32 v20, v240, v241, v242
    v_max_u32 v20, v20, v243
    v_max3_u32 v20, v244, v245, v20
    v_max3_u32 v20, v246, v247, v20
    v_max3_u32 v20, v248, v249, v20
    v_max3_u32 v20, v250, v251, v20
    v_max3_u32 v20, v252, v253, v20
    v_max3_u32 v20, v254, v255, v20
    v_cmp_eq_u32 vcc, -1, v20
    s_cbranch_vccz L_back3
L_sd3:
    s_sub_u32 s92, s92, 1
    s_cmp_eq_u32 s92, 0
    s_cbranch_scc1 L_back3
    s_sleep 2
    s_mov_b64 exec, 15
    v_lshlrev_b32 v240, 6, v21
    buffer_load_dword v241, v240, s[36:39], s94 offen offset:1020 sc1
    s_waitcnt vmcnt(0)
    v_cmp_eq_u32 vcc, -1, v241
    s_mov_b64 exec, -1
    s_cbranch_vccnz L_sd3
    s_branch L_sl3
L_slow4:
    s_movk_i32 s92, 20000
L_sl4:
    s_add_u32 s94, s87, 8192
    buffer_load_dwordx4 v[96:99], v21, s[36:39], s94 offen offset:0 sc1
    buffer_load_dwordx4 v[100:103], v21, s[36:39], s94 offen offset:1024 sc1
    buffer_load_dwordx4 v[104:107], v21, s[36:39], s94 offen offset:2048 sc1
    buffer_load_dwordx4 v[108:111], v21, s[36:39], s94 offen offset:3072 sc1
    s_waitcnt vmcnt(0)
    v_max3_u32 v20, v96, v97, v98
    v_max_u32 v20, v20, v99
    v_max3_u32 v20, v100, v101, v20
    v_max3_u32 v20, v102, v103, v20
    v_max3_u32 v20, v104, v105, v20
    v_max3_u32 v20, v106, v107, v20
    v_max3_u32 v20, v108, v109, v20
    v_max3_u32 v20, v110, v111, v20
    v_cmp_eq_u32 vcc, -1, v20
    s_cbranch_vccz L_back4
L_sd4:
    s_sub_u32 s92, s92, 1
    s_cmp_eq_u32 s92, 0
    s_cbranch_scc1 L_back4
    s_sleep 2
    s_mov_b64 exec, 15
    v_lshlrev_b32 v96, 6, v21
    buffer_load_dword v97, v96, s[36:39], s94 offen offset:1020 sc1
    s_waitcnt vmcnt(0)
    v_cmp_eq_u32 vcc, -1, v97
    s_mov_b64 exec, -1
    s_cbranch_vccnz L_sd4
    s_branch L_sl4
L_slow5:
    s_movk_i32 s92, 20000
L_sl5:
    s_add_u32 s94, s87, 12288
    buffer_load_dwordx4 v[112:115], v21, s[36:39], s94 offen offset:0 sc1
    buffer_load_dwordx4 v[116:119], v21, s[36:39], s94 offen offset:1024 sc1
    buffer_load_dwordx4 v[120:123], v21, s[36:39], s94 offen offset:2048 sc1
    buffer_load_dwordx4 v[124:127], v21, s[36:39], s94 offen offset:3072 sc1
    s_waitcnt vmcnt(0)
    v_max3_u32 v20, v112, v113, v114
    v_max_u32 v20, v20, v115
    v_max3_u32 v20, v116, v117, v20
    v_max3_u32 v20, v118, v119, v20
    v_max3_u32 v20, v120, v121, v20
    v_max3_u32 v20, v122, v123, v20
    v_max3_u32 v20, v124, v125, v20
    v_max3_u32 v20, v126, v127, v20
    v_cmp_eq_u32 vcc, -1, v20
    s_cbranch_vccz L_back5
L_sd5:
    s_sub_u32 s92, s92, 1
    s_cmp_eq_u32 s92, 0
    s_cbranch_scc1 L_back5
    s_sleep 2
    s_mov_b64 exec, 15
    v_lshlrev_b32 v112, 6, v21
    buffer_load_dword v113, v112, s[36:39], s94 offen offset:1020 sc1
    s_waitcnt vmcnt(0)
    v_cmp_eq_u32 vcc, -1, v113
    s_mov_b64 exec, -1
    s_cbranch_vccnz L_sd5
    s_branch L_sl5
L_slow6:
    s_movk_i32 s92, 20000
L_sl6:
    s_add_u32 s94, s87, 32768
    buffer_load_dwordx4 v[192:195], v21, s[36:39], s94 offen offset:0 sc1
    buffer_load_dwordx4 v[196:199], v21, s[36:39], s94 offen offset:1024 sc1
    buffer_load_dwordx4 v[200:203], v21, s[36:39], s94 offen offset:2048 sc1
    buffer_load_dwordx4 v[204:207], v21, s[36:39], s94 offen offset:3072 sc1
    s_waitcnt vmcnt(0)
    v_max3_u32 v20, v192, v193, v194
    v_max_u32 v20, v20, v195
    v_max3_u32 v20, v196, v197, v20
    v_max3_u32 v20, v198, v199, v20
    v_max3_u32 v20, v200, v201, v20
    v_max3_u32 v20, v202, v203, v20
    v_max3_u32 v20, v204, v205, v20
    v_max3_u32 v20, v206, v207, v20
    v_cmp_eq_u32 vcc, -1, v20
    s_cbranch_vccz L_back6
L_sd6:
    s_sub_u32 s92, s92, 1
    s_cmp_eq_u32 s92, 0
    s_cbranch_scc1 L_back6
    s_sleep 2
    s_mov_b64 exec, 15
    v_lshlrev_b32 v192, 6, v21
    buffer_load_dword v193, v192, s[36:39], s94 offen offset:1020 sc1
    s_waitcnt vmcnt(0)
    v_cmp_eq_u32 vcc, -1, v193
    s_mov_b64 exec, -1
    s_cbranch_vccnz L_sd6
    s_branch L_sl6
L_slow7:
    s_movk_i32 s92, 20000
L_sl7:
    s_add_u32 s94, s87, 36864
    buffer_load_dwordx4 v[208:211], v21, s[36:39], s94 offen offset:0 sc1
    buffer_load_dwordx4 v[212:215], v21, s[36:39], s94 offen offset:1024 sc1
    buffer_load_dwordx4 v[216:219], v21, s[36:39], s94 offen offset:2048 sc1
    buffer_load_dwordx4 v[220:223], v21, s[36:39], s94 offen offset:3072 sc1
    s_waitcnt vmcnt(0)
    v_max3_u32 v20, v208, v209, v210
    v_max_u32 v20, v20, v211
    v_max3_u32 v20, v212, v213, v20
    v_max3_u32 v20, v214, v215, v20
    v_max3_u32 v20, v216, v217, v20
    v_max3_u32 v20, v218, v219, v20
    v_max3_u32 v20, v220, v221, v20
    v_max3_u32 v20, v222, v223, v20
    v_cmp_eq_u32 vcc, -1, v20
    s_cbranch_vccz L_back7
L_sd7:
    s_sub_u32 s92, s92, 1
    s_cmp_eq_u32 s92, 0
    s_cbranch_scc1 L_back7
    s_sleep 2
    s_mov_b64 exec, 15
    v_lshlrev_b32 v208, 6, v21
    buffer_load_dword v209, v208, s[36:39], s94 offen offset:1020 sc1
    s_waitcnt vmcnt(0)
    v_cmp_eq_u32 vcc, -1, v209
    s_mov_b64 exec, -1
    s_cbranch_vccnz L_sd7
    s_branch L_sl7
L_slow8:
    s_movk_i32 s92, 20000
L_sl8:
    s_add_u32 s94, s87, 49152
    buffer_load_dwordx4 v[224:227], v21, s[36:39], s94 offen offset:0 sc1
    buffer_load_dwordx4 v[228:231], v21, s[36:39], s94 offen offset:1024 sc1
    buffer_load_dwordx4 v[232:235], v21, s[36:39], s94 offen offset:2048 sc1
    buffer_load_dwordx4 v[236:239], v21, s[36:39], s94 offen offset:3072 sc1
    s_waitcnt vmcnt(0)
    v_max3_u32 v20, v224, v225, v226
    v_max_u32 v20, v20, v227
    v_max3_u32 v20, v228, v229, v20
    v_max3_u32 v20, v230, v231, v20
    v_max3_u32 v20, v232, v233, v20
    v_max3_u32 v20, v234, v235, v20
    v_max3_u32 v20, v236, v237, v20
    v_max3_u32 v20, v238, v239, v20
    v_cmp_eq_u32 vcc, -1, v20
    s_cbranch_vccz L_back8
L_sd8:
    s_sub_u32 s92, s92, 1
    s_cmp_eq_u32 s92, 0
    s_cbranch_scc1 L_back8
    s_sleep 2
    s_mov_b64 exec, 15
    v_lshlrev_b32 v224, 6, v21
    buffer_load_dword v225, v224, s[36:39], s94 offen offset:1020 sc1
    s_waitcnt vmcnt(0)
    v_cmp_eq_u32 vcc, -1, v225
    s_mov_b64 exec, -1
    s_cbranch_vccnz L_sd8
    s_branch L_sl8
L_slow9:
    s_movk_i32 s92, 20000
L_sl9:
    s_add_u32 s94, s87, 53248
    buffer_load_dwordx4 v[240:243], v21, s[36:39], s94 offen offset:0 sc1
    buffer_load_dwordx4 v[244:247], v21, s[36:39], s94 offen offset:1024 sc1
    buffer_load_dwordx4 v[248:251], v21, s[36:39], s94 offen offset:2048 sc1
    buffer_load_dwordx4 v[252:255], v21, s[36:39], s94 offen offset:3072 sc1
    s_waitcnt vmcnt(0)
    v_max3_u32 v20, v240, v241, v242
    v_max_u32 v20, v20, v243
    v_max3_u32 v20, v244, v245, v20
    v_max3_u32 v20, v246, v247, v20
    v_max3_u32 v20, v248, v249, v20
    v_max3_u32 v20, v250, v251, v20
    v_max3_u32 v20, v252, v253, v20
    v_max3_u32 v20, v254, v255, v20
    v_cmp_eq_u32 vcc, -1, v20
    s_cbranch_vccz L_back9
L_sd9:
    s_sub_u32 s92, s92, 1
    s_cmp_eq_u32 s92, 0
    s_cbranch_scc1 L_back9
    s_sleep 2
    s_mov_b64 exec, 15
    v_lshlrev_b32 v240, 6, v21
    buffer_load_dword v241, v240, s[36:39], s94 offen offset:1020 sc1
    s_waitcnt vmcnt(0)
    v_cmp_eq_u32 vcc, -1, v241
    s_mov_b64 exec, -1
    s_cbranch_vccnz L_sd9
    s_branch L_sl9
L_slow10:
    s_movk_i32 s92, 20000
L_sl10:
    s_add_u32 s94, s87, 73728
    buffer_load_dwordx4 v[96:99], v21, s[36:39], s94 offen offset:0 sc1
    buffer_load_dwordx4 v[100:103], v21, s[36:39], s94 offen offset:1024 sc1
    buffer_load_dwordx4 v[104:107], v21, s[36:39], s94 offen offset:2048 sc1
    buffer_load_dwordx4 v[108:111], v21, s[36:39], s94 offen offset:3072 sc1
    s_waitcnt vmcnt(0)
    v_max3_u32 v20, v96, v97, v98
    v_max_u32 v20, v20, v99
    v_max3_u32 v20, v100, v101, v20
    v_max3_u32 v20, v102, v103, v20
    v_max3_u32 v20, v104, v105, v20
    v_max3_u32 v20, v106, v107, v20
    v_max3_u32 v20, v108, v109, v20
    v_max3_u32 v20, v110, v111, v20
    v_cmp_eq_u32 vcc, -1, v20
    s_cbranch_vccz L_back10
L_sd10:
    s_sub_u32 s92, s92, 1
    s_cmp_eq_u32 s92, 0
    s_cbranch_scc1 L_back10
    s_sleep 2
    s_mov_b64 exec, 15
    v_lshlrev_b32 v96, 6, v21
    buffer_load_dword v97, v96, s[36:39], s94 offen offset:1020 sc1
    s_waitcnt vmcnt(0)
    v_cmp_eq_u32 vcc, -1, v97
    s_mov_b64 exec, -1
    s_cbranch_vccnz L_sd10
    s_branch L_sl10
L_slow11:
    s_movk_i32 s92, 20000
L_sl11:
    s_add_u32 s94, s87, 77824
    buffer_load_dwordx4 v[112:115], v21, s[36:39], s94 offen offset:0 sc1
    buffer_load_dwordx4 v[116:119], v21, s[36:39], s94 offen offset:1024 sc1
    buffer_load_dwordx4 v[120:123], v21, s[36:39], s94 offen offset:2048 sc1
    buffer_load_dwordx4 v[124:127], v21, s[36:39], s94 offen offset:3072 sc1
    s_waitcnt vmcnt(0)
    v_max3_u32 v20, v112, v113, v114
    v_max_u32 v20, v20, v115
    v_max3_u32 v20, v116, v117, v20
    v_max3_u32 v20, v118, v119, v20
    v_max3_u32 v20, v120, v121, v20
    v_max3_u32 v20, v122, v123, v20
    v_max3_u32 v20, v124, v125, v20
    v_max3_u32 v20, v126, v127, v20
    v_cmp_eq_u32 vcc, -1, v20
    s_cbranch_vccz L_back11
L_sd11:
    s_sub_u32 s92, s92, 1
    s_cmp_eq_u32 s92, 0
    s_cbranch_scc1 L_back11
    s_sleep 2
    s_mov_b64 exec, 15
    v_lshlrev_b32 v112, 6, v21
    buffer_load_dword v113, v112, s[36:39], s94 offen offset:1020 sc1
    s_waitcnt vmcnt(0)
    v_cmp_eq_u32 vcc, -1, v113
    s_mov_b64 exec, -1
    s_cbranch_vccnz L_sd11
    s_branch L_sl11
L_slow12:
    s_movk_i32 s92, 20000
L_sl12:
    s_add_u32 s94, s87, 57344
    buffer_load_dwordx4 v[192:195], v21, s[36:39], s94 offen offset:0 sc1
    buffer_load_dwordx4 v[196:199], v21, s[36:39], s94 offen offset:1024 sc1
    buffer_load_dwordx4 v[200:203], v21, s[36:39], s94 offen offset:2048 sc1
    buffer_load_dwordx4 v[204:207], v21, s[36:39], s94 offen offset:3072 sc1
    s_waitcnt vmcnt(0)
    v_max3_u32 v20, v192, v193, v194
    v_max_u32 v20, v20, v195
    v_max3_u32 v20, v196, v197, v20
    v_max3_u32 v20, v198, v199, v20
    v_max3_u32 v20, v200, v201, v20
    v_max3_u32 v20, v202, v203, v20
    v_max3_u32 v20, v204, v205, v20
    v_max3_u32 v20, v206, v207, v20
    v_cmp_eq_u32 vcc, -1, v20
    s_cbranch_vccz L_back12
L_sd12:
    s_sub_u32 s92, s92, 1
    s_cmp_eq_u32 s92, 0
    s_cbranch_scc1 L_back12
    s_sleep 2
    s_mov_b64 exec, 15
    v_lshlrev_b32 v192, 6, v21
    buffer_load_dword v193, v192, s[36:39], s94 offen offset:1020 sc1
    s_waitcnt vmcnt(0)
    v_cmp_eq_u32 vcc, -1, v193
    s_mov_b64 exec, -1
    s_cbranch_vccnz L_sd12
    s_branch L_sl12
L_slow13:
    s_movk_i32 s92, 20000
L_sl13:
    s_add_u32 s94, s87, 61440
    buffer_load_dwordx4 v[208:211], v21, s[36:39], s94 offen offset:0 sc1
    buffer_load_dwordx4 v[212:215], v21, s[36:39], s94 offen offset:1024 sc1
    buffer_load_dwordx4 v[216:219], v21, s[36:39], s94 offen offset:2048 sc1
    buffer_load_dwordx4 v[220:223], v21, s[36:39], s94 offen offset:3072 sc1
    s_waitcnt vmcnt(0)
    v_max3_u32 v20, v208, v209, v210
    v_max_u32 v20, v20, v211
    v_max3_u32 v20, v212, v213, v20
    v_max3_u32 v20, v214, v215, v20
    v_max3_u32 v20, v216, v217, v20
    v_max3_u32 v20, v218, v219, v20
    v_max3_u32 v20, v220, v221, v20
    v_max3_u32 v20, v222, v223, v20
    v_cmp_eq_u32 vcc, -1, v20
    s_cbranch_vccz L_back13
L_sd13:
    s_sub_u32 s92, s92, 1
    s_cmp_eq_u32 s92, 0
    s_cbranch_scc1 L_back13
    s_sleep 2
    s_mov_b64 exec, 15
    v_lshlrev_b32 v208, 6, v21
    buffer_load_dword v209, v208, s[36:39], s94 offen offset:1020 sc1
    s_waitcnt vmcnt(0)
    v_cmp_eq_u32 vcc, -1, v209
    s_mov_b64 exec, -1
    s_cbranch_vccnz L_sd13
    s_branch L_sl13
L_slow14:
    s_movk_i32 s92, 20000
L_sl14:
    s_add_u32 s94, s87, 81920
    buffer_load_dwordx4 v[224:227], v21, s[36:39], s94 offen offset:0 sc1
    buffer_load_dwordx4 v[228:231], v21, s[36:39], s94 offen offset:1024 sc1
    buffer_load_dwordx4 v[232:235], v21, s[36:39], s94 offen offset:2048 sc1
    buffer_load_dwordx4 v[236:239], v21, s[36:39], s94 offen offset:3072 sc1
    s_waitcnt vmcnt(0)
    v_max3_u32 v20, v224, v225, v226
    v_max_u32 v20, v20, v227
    v_max3_u32 v20, v228, v229, v20
    v_max3_u32 v20, v230, v231, v20
    v_max3_u32 v20, v232, v233, v20
    v_max3_u32 v20, v234, v235, v20
    v_max3_u32 v20, v236, v237, v20
    v_max3_u32 v20, v238, v239, v20
    v_cmp_eq_u32 vcc, -1, v20
    s_cbranch_vccz L_back14
L_sd14:
    s_sub_u32 s92, s92, 1
    s_cmp_eq_u32 s92, 0
    s_cbranch_scc1 L_back14
    s_sleep 2
    s_mov_b64 exec, 15
    v_lshlrev_b32 v224, 6, v21
    buffer_load_dword v225, v224, s[36:39], s94 offen offset:1020 sc1
    s_waitcnt vmcnt(0)
    v_cmp_eq_u32 vcc, -1, v225
    s_mov_b64 exec, -1
    s_cbranch_vccnz L_sd14
    s_branch L_sl14
L_slow15:
    s_movk_i32 s92, 20000
L_sl15:
    s_add_u32 s94, s87, 86016
    buffer_load_dwordx4 v[240:243], v21, s[36:39], s94 offen offset:0 sc1
    buffer_load_dwordx4 v[244:247], v21, s[36:39], s94 offen offset:1024 sc1
    buffer_load_dwordx4 v[248:251], v21, s[36:39], s94 offen offset:2048 sc1
    buffer_load_dwordx4 v[252:255], v21, s[36:39], s94 offen offset:3072 sc1
    s_waitcnt vmcnt(0)
    v_max3_u32 v20, v240, v241, v242
    v_max_u32 v20, v20, v243
    v_max3_u32 v20, v244, v245, v20
    v_max3_u32 v20, v246, v247, v20
    v_max3_u32 v20, v248, v249, v20
    v_max3_u32 v20, v250, v251, v20
    v_max3_u32 v20, v252, v253, v20
    v_max3_u32 v20, v254, v255, v20
    v_cmp_eq_u32 vcc, -1, v20
    s_cbranch_vccz L_back15
L_sd15:
    s_sub_u32 s92, s92, 1
    s_cmp_eq_u32 s92, 0
    s_cbranch_scc1 L_back15
    s_sleep 2
    s_mov_b64 exec, 15
    v_lshlrev_b32 v240, 6, v21
    buffer_load_dword v241, v240, s[36:39], s94 offen offset:1020 sc1
    s_waitcnt vmcnt(0)
    v_cmp_eq_u32 vcc, -1, v241
    s_mov_b64 exec, -1
    s_cbranch_vccnz L_sd15
    s_branch L_sl15
L_slow16:
    s_movk_i32 s92, 20000
L_sl16:
    s_add_u32 s94, s87, 16384
    buffer_load_dwordx4 v[96:99], v21, s[36:39], s94 offen offset:0 sc1
    buffer_load_dwordx4 v[100:103], v21, s[36:39], s94 offen offset:1024 sc1
    buffer_load_dwordx4 v[104:107], v21, s[36:39], s94 offen offset:2048 sc1
    buffer_load_dwordx4 v[108:111], v21, s[36:39], s94 offen offset:3072 sc1
    s_waitcnt vmcnt(0)
    v_max3_u32 v20, v96, v97, v98
    v_max_u32 v20, v20, v99
    v_max3_u32 v20, v100, v101, v20
    v_max3_u32 v20, v102, v103, v20
    v_max3_u32 v20, v104, v105, v20
    v_max3_u32 v20, v106, v107, v20
    v_max3_u32 v20, v108, v109, v20
    v_max3_u32 v20, v110, v111, v20
    v_cmp_eq_u32 vcc, -1, v20
    s_cbranch_vccz L_back16
L_sd16:
    s_sub_u32 s92, s92, 1
    s_cmp_eq_u32 s92, 0
    s_cbranch_scc1 L_back16
    s_sleep 2
    s_mov_b64 exec, 15
    v_lshlrev_b32 v96, 6, v21
    buffer_load_dword v97, v96, s[36:39], s94 offen offset:1020 sc1
    s_waitcnt vmcnt(0)
    v_cmp_eq_u32 vcc, -1, v97
    s_mov_b64 exec, -1
    s_cbranch_vccnz L_sd16
    s_branch L_sl16
L_slow17:
    s_movk_i32 s92, 20000
L_sl17:
    s_add_u32 s94, s87, 20480
    buffer_load_dwordx4 v[112:115], v21, s[36:39], s94 offen offset:0 sc1
    buffer_load_dwordx4 v[116:119], v21, s[36:39], s94 offen offset:1024 sc1
    buffer_load_dwordx4 v[120:123], v21, s[36:39], s94 offen offset:2048 sc1
    buffer_load_dwordx4 v[124:127], v21, s[36:39], s94 offen offset:3072 sc1
    s_waitcnt vmcnt(0)
    v_max3_u32 v20, v112, v113, v114
    v_max_u32 v20, v20, v115
    v_max3_u32 v20, v116, v117, v20
    v_max3_u32 v20, v118, v119, v20
    v_max3_u32 v20, v120, v121, v20
    v_max3_u32 v20, v122, v123, v20
    v_max3_u32 v20, v124, v125, v20
    v_max3_u32 v20, v126, v127, v20
    v_cmp_eq_u32 vcc, -1, v20
    s_cbranch_vccz L_back17
L_sd17:
    s_sub_u32 s92, s92, 1
    s_cmp_eq_u32 s92, 0
    s_cbranch_scc1 L_back17
    s_sleep 2
    s_mov_b64 exec, 15
    v_lshlrev_b32 v112, 6, v21
    buffer_load_dword v113, v112, s[36:39], s94 offen offset:1020 sc1
    s_waitcnt vmcnt(0)
    v_cmp_eq_u32 vcc, -1, v113
    s_mov_b64 exec, -1
    s_cbranch_vccnz L_sd17
    s_branch L_sl17
L_slow18:
    s_movk_i32 s92, 20000
L_sl18:
    s_add_u32 s94, s87, 40960
    buffer_load_dwordx4 v[192:195], v21, s[36:39], s94 offen offset:0 sc1
    buffer_load_dwordx4 v[196:199], v21, s[36:39], s94 offen offset:1024 sc1
    buffer_load_dwordx4 v[200:203], v21, s[36:39], s94 offen offset:2048 sc1
    buffer_load_dwordx4 v[204:207], v21, s[36:39], s94 offen offset:3072 sc1
    s_waitcnt vmcnt(0)
    v_max3_u32 v20, v192, v193, v194
    v_max_u32 v20, v20, v195
    v_max3_u32 v20, v196, v197, v20
    v_max3_u32 v20, v198, v199, v20
    v_max3_u32 v20, v200, v201, v20
    v_max3_u32 v20, v202, v203, v20
    v_max3_u32 v20, v204, v205, v20
    v_max3_u32 v20, v206, v207, v20
    v_cmp_eq_u32 vcc, -1, v20
    s_cbranch_vccz L_back18
L_sd18:
    s_sub_u32 s92, s92, 1
    s_cmp_eq_u32 s92, 0
    s_cbranch_scc1 L_back18
    s_sleep 2
    s_mov_b64 exec, 15
    v_lshlrev_b32 v192, 6, v21
    buffer_load_dword v193, v192, s[36:39], s94 offen offset:1020 sc1
    s_waitcnt vmcnt(0)
    v_cmp_eq_u32 vcc, -1, v193
    s_mov_b64 exec, -1
    s_cbranch_vccnz L_sd18
    s_branch L_sl18
L_slow19:
    s_movk_i32 s92, 20000
L_sl19:
    s_add_u32 s94, s87, 45056
    buffer_load_dwordx4 v[208:211], v21, s[36:39], s94 offen offset:0 sc1
    buffer_load_dwordx4 v[212:215], v21, s[36:39], s94 offen offset:1024 sc1
    buffer_load_dwordx4 v[216:219], v21, s[36:39], s94 offen offset:2048 sc1
    buffer_load_dwordx4 v[220:223], v21, s[36:39], s94 offen offset:3072 sc1
    s_waitcnt vmcnt(0)
    v_max3_u32 v20, v208, v209, v210
    v_max_u32 v20, v20, v211
    v_max3_u32 v20, v212, v213, v20
    v_max3_u32 v20, v214, v215, v20
    v_max3_u32 v20, v216, v217, v20
    v_max3_u32 v20, v218, v219, v20
    v_max3_u32 v20, v220, v221, v20
    v_max3_u32 v20, v222, v223, v20
    v_cmp_eq_u32 vcc, -1, v20
    s_cbranch_vccz L_back19
L_sd19:
    s_sub_u32 s92, s92, 1
    s_cmp_eq_u32 s92, 0
    s_cbranch_scc1 L_back19
    s_sleep 2
    s_mov_b64 exec, 15
    v_lshlrev_b32 v208, 6, v21
    buffer_load_dword v209, v208, s[36:39], s94 offen offset:1020 sc1
    s_waitcnt vmcnt(0)
    v_cmp_eq_u32 vcc, -1, v209
    s_mov_b64 exec, -1
    s_cbranch_vccnz L_sd19
    s_branch L_sl19
L_slow20:
    s_movk_i32 s92, 20000
L_sl20:
    s_add_u32 s94, s87, 65536
    buffer_load_dwordx4 v[224:227], v21, s[36:39], s94 offen offset:0 sc1
    buffer_load_dwordx4 v[228:231], v21, s[36:39], s94 offen offset:1024 sc1
    buffer_load_dwordx4 v[232:235], v21, s[36:39], s94 offen offset:2048 sc1
    buffer_load_dwordx4 v[236:239], v21, s[36:39], s94 offen offset:3072 sc1
    s_waitcnt vmcnt(0)
    v_max3_u32 v20, v224, v225, v226
    v_max_u32 v20, v20, v227
    v_max3_u32 v20, v228, v229, v20
    v_max3_u32 v20, v230, v231, v20
    v_max3_u32 v20, v232, v233, v20
    v_max3_u32 v20, v234, v235, v20
    v_max3_u32 v20, v236, v237, v20
    v_max3_u32 v20, v238, v239, v20
    v_cmp_eq_u32 vcc, -1, v20
    s_cbranch_vccz L_back20
L_sd20:
    s_sub_u32 s92, s92, 1
    s_cmp_eq_u32 s92, 0
    s_cbranch_scc1 L_back20
    s_sleep 2
    s_mov_b64 exec, 15
    v_lshlrev_b32 v224, 6, v21
    buffer_load_dword v225, v224, s[36:39], s94 offen offset:1020 sc1
    s_waitcnt vmcnt(0)
    v_cmp_eq_u32 vcc, -1, v225
    s_mov_b64 exec, -1
    s_cbranch_vccnz L_sd20
    s_branch L_sl20
L_slow21:
    s_movk_i32 s92, 20000
L_sl21:
    s_add_u32 s94, s87, 69632
    buffer_load_dwordx4 v[240:243], v21, s[36:39], s94 offen offset:0 sc1
    buffer_load_dwordx4 v[244:247], v21, s[36:39], s94 offen offset:1024 sc1
    buffer_load_dwordx4 v[248:251], v21, s[36:39], s94 offen offset:2048 sc1
    buffer_load_dwordx4 v[252:255], v21, s[36:39], s94 offen offset:3072 sc1
    s_waitcnt vmcnt(0)
    v_max3_u32 v20, v240, v241, v242
    v_max_u32 v20, v20, v243
    v_max3_u32 v20, v244, v245, v20
    v_max3_u32 v20, v246, v247, v20
    v_max3_u32 v20, v248, v249, v20
    v_max3_u32 v20, v250, v251, v20
    v_max3_u32 v20, v252, v253, v20
    v_max3_u32 v20, v254, v255, v20
    v_cmp_eq_u32 vcc, -1, v20
    s_cbranch_vccz L_back21
L_sd21:
    s_sub_u32 s92, s92, 1
    s_cmp_eq_u32 s92, 0
    s_cbranch_scc1 L_back21
    s_sleep 2
    s_mov_b64 exec, 15
    v_lshlrev_b32 v240, 6, v21
    buffer_load_dword v241, v240, s[36:39], s94 offen offset:1020 sc1
    s_waitcnt vmcnt(0)
    v_cmp_eq_u32 vcc, -1, v241
    s_mov_b64 exec, -1
    s_cbranch_vccnz L_sd21
    s_branch L_sl21
L_slow22:
    s_movk_i32 s92, 20000
L_sl22:
    s_add_u32 s94, s87, 90112
    buffer_load_dwordx4 v[96:99], v21, s[36:39], s94 offen offset:0 sc1
    buffer_load_dwordx4 v[100:103], v21, s[36:39], s94 offen offset:1024 sc1
    buffer_load_dwordx4 v[104:107], v21, s[36:39], s94 offen offset:2048 sc1
    buffer_load_dwordx4 v[108:111], v21, s[36:39], s94 offen offset:3072 sc1
    s_waitcnt vmcnt(0)
    v_max3_u32 v20, v96, v97, v98
    v_max_u32 v20, v20, v99
    v_max3_u32 v20, v100, v101, v20
    v_max3_u32 v20, v102, v103, v20
    v_max3_u32 v20, v104, v105, v20
    v_max3_u32 v20, v106, v107, v20
    v_max3_u32 v20, v108, v109, v20
    v_max3_u32 v20, v110, v111, v20
    v_cmp_eq_u32 vcc, -1, v20
    s_cbranch_vccz L_back22
L_sd22:
    s_sub_u32 s92, s92, 1
    s_cmp_eq_u32 s92, 0
    s_cbranch_scc1 L_back22
    s_sleep 2
    s_mov_b64 exec, 15
    v_lshlrev_b32 v96, 6, v21
    buffer_load_dword v97, v96, s[36:39], s94 offen offset:1020 sc1
    s_waitcnt vmcnt(0)
    v_cmp_eq_u32 vcc, -1, v97
    s_mov_b64 exec, -1
    s_cbranch_vccnz L_sd22
    s_branch L_sl22
L_slow23:
    s_movk_i32 s92, 20000
L_sl23:
    s_add_u32 s94, s87, 94208
    buffer_load_dwordx4 v[112:115], v21, s[36:39], s94 offen offset:0 sc1
    buffer_load_dwordx4 v[116:119], v21, s[36:39], s94 offen offset:1024 sc1
    buffer_load_dwordx4 v[120:123], v21, s[36:39], s94 offen offset:2048 sc1
    buffer_load_dwordx4 v[124:127], v21, s[36:39], s94 offen offset:3072 sc1
    s_waitcnt vmcnt(0)
    v_max3_u32 v20, v112, v113, v114
    v_max_u32 v20, v20, v115
    v_max3_u32 v20, v116, v117, v20
    v_max3_u32 v20, v118, v119, v20
    v_max3_u32 v20, v120, v121, v20
    v_max3_u32 v20, v122, v123, v20
    v_max3_u32 v20, v124, v125, v20
    v_max3_u32 v20, v126, v127, v20
    v_cmp_eq_u32 vcc, -1, v20
    s_cbranch_vccz L_back23
L_sd23:
    s_sub_u32 s92, s92, 1
    s_cmp_eq_u32 s92, 0
    s_cbranch_scc1 L_back23
    s_sleep 2
    s_mov_b64 exec, 15
    v_lshlrev_b32 v112, 6, v21
    buffer_load_dword v113, v112, s[36:39], s94 offen offset:1020 sc1
    s_waitcnt vmcnt(0)
    v_cmp_eq_u32 vcc, -1, v113
    s_mov_b64 exec, -1
    s_cbranch_vccnz L_sd23
    s_branch L_sl23
    s_endpgm

.section .rodata,"a"
.p2align 6
.amdhsa_kernel standalone__mha_block_cached__near_ridge_kernel
  .amdhsa_next_free_vgpr 512
  .amdhsa_next_free_sgpr 102
  .amdhsa_accum_offset 256
  .amdhsa_group_segment_fixed_size 0
  .amdhsa_kernarg_size 64
  .amdhsa_user_sgpr_count 2
  .amdhsa_user_sgpr_kernarg_segment_ptr 1
  .amdhsa_system_sgpr_workgroup_id_x 1
.end_amdhsa_kernel
```
